```python
import torch

def _softmax(x, axis=-1):
    return torch.softmax(x, dim=axis)
def _gelu(x):
    return torch.nn.functional.gelu(x, approximate="tanh")
def _silu(x):
    return torch.nn.functional.silu(x)
def _sigmoid(x):
    return torch.sigmoid(x)
def _layernorm(x, axis=-1, eps=1e-5):
    m = x.mean(dim=axis, keepdim=True)
    v = x.var(dim=axis, keepdim=True, unbiased=False)
    return (x - m) / torch.sqrt(v + eps)
def _scatter_add(tgt, idx, src, axis=0):
    return tgt.clone().index_add_(axis, idx, src)
def _segment_sum(src, seg, n):
    out = torch.zeros((n,) + src.shape[1:], dtype=src.dtype)
    return out.index_add_(0, seg, src)
def _pad(x, pw):
    flat = tuple(v for pair in reversed(pw) for v in pair)
    return torch.nn.functional.pad(x, flat)

kernel_name = 'sequential_preLN__compressed_kv_cla__swiglu_ffn__decode'

def setup_inputs():

    _w = (lambda a: (lambda t: t.to(torch.bfloat16) if t.is_floating_point() else t)(torch.as_tensor(a)))
    def _A_setup():
        B, H, Sq, Sk, D, M = 4, 32, 1, 4096, 128, 512
        Dc = 4 * D
        return {
            "x": _w((lambda *s: torch.randn(*s, dtype=torch.bfloat16) * 0.05)(B, Sq, M)),
            "c_kv": _w((lambda *s: torch.randn(*s, dtype=torch.bfloat16) * 0.4)(B, Sk, Dc)),
            "w_q": _w((lambda *s: torch.randn(*s, dtype=torch.bfloat16) * 3.2)(M, H, D) * (M ** -0.5)),
            "w_uk": _w((lambda *s: torch.randn(*s, dtype=torch.bfloat16) * 3.2)(Dc, H, D) * (Dc ** -0.5)),
            "w_uv": _w((lambda *s: torch.randn(*s, dtype=torch.bfloat16) * 0.4)(Dc, H, D) * (Dc ** -0.5)),
            "w_o": _w((lambda *s: torch.randn(*s, dtype=torch.bfloat16) * 0.4)(H, D, M) * ((H * D) ** -0.5)),
        }
    _A_in = _A_setup()

    def _B_setup():
        B, S, D, F = 4, 1, 512, 1792
        return {
            "x": _w((lambda *s: torch.randn(*s, dtype=torch.bfloat16) * 0.05)(B, S, D)),
            "w_gate": _w((lambda *s: torch.randn(*s, dtype=torch.bfloat16) * 0.05)(D, F)),
            "w_up": _w((lambda *s: torch.randn(*s, dtype=torch.bfloat16) * 0.05)(D, F)),
            "w_down": _w((lambda *s: torch.randn(*s, dtype=torch.bfloat16) * 0.05)(F, D)),
        }
    _B_in = _B_setup()

    return {
        "A_x": _A_in["x"],
        "A_c_kv": _A_in["c_kv"],
        "A_w_q": _A_in["w_q"],
        "A_w_uk": _A_in["w_uk"],
        "A_w_uv": _A_in["w_uv"],
        "A_w_o": _A_in["w_o"],
        "B_x": _B_in["x"],
        "B_w_gate": _B_in["w_gate"],
        "B_w_up": _B_in["w_up"],
        "B_w_down": _B_in["w_down"],
    }

def reference(A_x, A_c_kv, A_w_q, A_w_uk, A_w_uv, A_w_o, B_x, B_w_gate, B_w_up, B_w_down):
    def _A_ref(x, c_kv, w_q, w_uk, w_uv, w_o):
        B, Sq, M = x.shape[0], x.shape[1], x.shape[2]
        Sk = c_kv.shape[1]
        H, D = w_q.shape[1], w_q.shape[2]
        q = torch.einsum("bqm,mhd->bhqd", x, w_q)
        k = torch.einsum("bkc,chd->bhkd", c_kv, w_uk)
        v = torch.einsum("bkc,chd->bhkd", c_kv, w_uv)
        scores = torch.einsum("bhqd,bhkd->bhqk", q, k) * (D ** -0.5)
        off = Sk - Sq
        qi = torch.arange(Sq)[:, None]
        kj = torch.arange(Sk)[None, :]
        cmask = kj <= (qi + off)
        scores = torch.where(cmask[None, None], scores, -1e9)
        p = _softmax(scores, axis=-1)
        ctx = torch.einsum("bhqk,bhkd->bhqd", p, v)
        return torch.einsum("bhqd,hdm->bqm", ctx, w_o)

    def _B_ref(x, w_gate, w_up, w_down):
        g = _silu(x @ w_gate)
        u = x @ w_up
        return (g * u) @ w_down

    x = A_x
    h = x + _A_ref(_layernorm(x, axis=-1), A_c_kv, A_w_q, A_w_uk, A_w_uv, A_w_o)
    h2 = h + _B_ref(_layernorm(h, axis=-1), B_w_gate, B_w_up, B_w_down)
    return h2
```

```asm
; @launch grid=(256,1,1) block=(512,1,1) lds=163840
.amdgcn_target "amdgcn-amd-amdhsa--gfx950"
.text
.globl sequential_preLN__compressed_kv_cla__swiglu_ffn__decode_kernel
.p2align 8
.type sequential_preLN__compressed_kv_cla__swiglu_ffn__decode_kernel,@function
sequential_preLN__compressed_kv_cla__swiglu_ffn__decode_kernel:
    s_cmp_ge_u32 s2, 256
    s_cbranch_scc1 L_exit
    s_load_dwordx16 s[4:19], s[0:1], 0
    s_load_dwordx8 s[20:27], s[0:1], 64
    s_load_dwordx2 s[28:29], s[0:1], 96
    v_lshrrev_b32 v4, 6, v0
    v_and_b32 v1, 63, v0
    v_readfirstlane_b32 s53, v4
    v_lshrrev_b32 v2, 4, v1
    v_and_b32 v3, 15, v1
    s_mov_b32 s64, 0x05040100
    s_mov_b32 s65, 0x07060302
    s_mov_b32 s66, 0x0c0c0400
    s_mov_b32 s67, 0x04000c0c
    s_mov_b32 s68, 0x7060500
    s_mov_b32 s69, 0x7060501
    s_mov_b32 s70, 0x7060502
    s_mov_b32 s71, 0x7060503
    s_mov_b32 s72, 0xffff0000
    v_mov_b32 v6, 0
    s_and_b32 s58, s2, 7
    s_lshr_b32 s59, s2, 4
    s_lshl_b32 s58, s58, 4
    s_add_u32 s54, s58, s59
    s_waitcnt lgkmcnt(0)
    s_mov_b32 s32, s28
    s_and_b32 s33, s29, 0xffff
    s_mov_b32 s34, 0x1000000
    s_mov_b32 s35, 0x20000
    s_mov_b32 s44, s4
    s_and_b32 s45, s5, 0xffff
    s_mov_b32 s46, 0x1000
    s_mov_b32 s47, 0x20000
    s_lshr_b32 s55, s54, 2
    s_and_b32 s56, s54, 3
    s_lshl_b32 s60, s55, 8
    s_bitcmp1_b32 s2, 3
    s_cbranch_scc0 L_Wi
    s_cmp_lt_u32 s53, 4
    s_cbranch_scc1 L_T_a1done
    v_lshlrev_b32 v7, 10, v2
    v_lshl_add_u32 v7, v3, 4, v7
    buffer_load_dwordx4 v[128:131], v7, s[44:47], 0 offen offset:0
    buffer_load_dwordx4 v[132:135], v7, s[44:47], 0 offen offset:256
    buffer_load_dwordx4 v[136:139], v7, s[44:47], 0 offen offset:512
    buffer_load_dwordx4 v[140:143], v7, s[44:47], 0 offen offset:768
    s_mov_b32 s36, s8
    s_and_b32 s37, s9, 0xffff
    s_mov_b32 s38, 0x400000
    s_mov_b32 s39, 0x20000
    v_lshlrev_b32 v29, 4, v3
    v_lshl_add_u32 v29, v2, 16, v29
    s_and_b32 s61, s53, 3
    s_lshl2_add_u32 s58, s56, s61
    s_lshl_b32 s59, s58, 18
    s_add_u32 s59, s59, s60
    buffer_load_dword v5, v6, s[32:35], 0 offen sc1
    buffer_load_dwordx4 v[32:35], v29, s[36:39], s59 offen nt
    s_addk_i32 s59, 8192
    buffer_load_dwordx4 v[36:39], v29, s[36:39], s59 offen nt
    s_addk_i32 s59, 8192
    buffer_load_dwordx4 v[40:43], v29, s[36:39], s59 offen nt
    s_addk_i32 s59, 8192
    buffer_load_dwordx4 v[44:47], v29, s[36:39], s59 offen nt
    s_addk_i32 s59, 8192
    buffer_load_dwordx4 v[48:51], v29, s[36:39], s59 offen nt
    s_addk_i32 s59, 8192
    buffer_load_dwordx4 v[52:55], v29, s[36:39], s59 offen nt
    s_addk_i32 s59, 8192
    buffer_load_dwordx4 v[56:59], v29, s[36:39], s59 offen nt
    s_addk_i32 s59, 8192
    buffer_load_dwordx4 v[60:63], v29, s[36:39], s59 offen nt
    v_mov_b32 v24, 0x3f803f80
    v_mov_b32 v25, 0x3f803f80
    v_mov_b32 v26, 0x3f803f80
    v_mov_b32 v27, 0x3f803f80
    v_lshlrev_b32 v28, 10, v3
    v_lshl_add_u32 v28, v2, 4, v28
    s_lshl_b32 s59, s58, 6
    s_mov_b32 exec_lo, 0xf000f
    s_mov_b32 exec_hi, 0xf000f
    buffer_load_dwordx4 v[24:27], v28, s[44:47], s59 offen
    s_mov_b64 exec, -1
    s_branch L_T_a1
L_Wi:
    s_cmp_lt_u32 s53, 6
    s_cbranch_scc1 L_W_idle
    s_mov_b32 s36, s10
    s_and_b32 s37, s11, 0xffff
    s_mov_b32 s38, 0x400000
    s_mov_b32 s39, 0x20000
    buffer_load_dword v5, v6, s[32:35], 0 offen sc1
    v_lshlrev_b32 v7, 2, v2
    v_xor_b32 v7, v7, v3
    v_lshlrev_b32 v7, 4, v7
    v_lshl_add_u32 v152, v2, 13, v7
    s_lshl_b32 s58, s56, 1
    s_add_u32 s58, s58, s53
    s_sub_u32 s58, s58, 6
    s_lshl_b32 s59, s58, 19
    s_add_u32 s59, s59, s60
    s_and_b32 s73, s53, 1
    s_lshl_b32 s73, s73, 14
    s_add_u32 s73, s73, 32768
    s_mov_b32 m0, s73
    s_mov_b32 s74, 0
    s_mov_b32 s75, 0x8000
    s_waitcnt vmcnt(0)
L_Wi_qa_loop:
    v_xor_b32 v153, s74, v152
    buffer_load_dwordx4 v153, s[36:39], s59 offen nt lds
    s_addk_i32 m0, 1024
    s_add_u32 s59, s59, s75
    buffer_load_dwordx4 v153, s[36:39], s59 offen nt lds
    s_addk_i32 m0, 1024
    s_add_u32 s59, s59, s75
    buffer_load_dwordx4 v153, s[36:39], s59 offen nt lds
    s_addk_i32 m0, 1024
    s_add_u32 s59, s59, s75
    buffer_load_dwordx4 v153, s[36:39], s59 offen nt lds
    s_addk_i32 m0, 1024
    s_add_u32 s59, s59, s75
    s_addk_i32 s74, 16
    s_cmp_lt_u32 s74, 64
    s_cbranch_scc1 L_Wi_qa_loop
    s_branch L_W_qa2
L_T_a1:
    v_lshlrev_b32 v29, 7, v2
    v_lshl_add_u32 v29, v3, 4, v29
    s_lshl_b32 s58, s61, 12
    s_add_u32 s58, s58, 131072
    v_add_u32 v29, s58, v29
    v_bfe_u32 v161, v0, 2, 5
    v_lshlrev_b32 v161, 7, v161
    v_add_u32 v161, 131072, v161
    v_and_b32 v162, 3, v1
    v_lshl_add_u32 v163, v162, 4, v161
    v_lshlrev_b32 v162, 6, v162
    v_and_b32 v7, 127, v0
    v_lshlrev_b32 v7, 4, v7
    s_lshl_b32 s59, s54, 11
    s_add_u32 s59, s59, 0x1000
    s_add_u32 s73, s59, 0x600000
    s_waitcnt vmcnt(9)
    v_add_u32 v5, 0x9e3779b1, v5
    v_mov_b32 v148, 0x3f803f80
    v_dot2_f32_bf16 v144, v128, v148, 0
    v_dot2_f32_bf16 v146, v128, v128, 0
    v_dot2_f32_bf16 v145, v129, v148, 0
    v_dot2_f32_bf16 v147, v129, v129, 0
    v_dot2_f32_bf16 v144, v130, v148, v144
    v_dot2_f32_bf16 v146, v130, v130, v146
    v_dot2_f32_bf16 v145, v131, v148, v145
    v_dot2_f32_bf16 v147, v131, v131, v147
    v_dot2_f32_bf16 v144, v132, v148, v144
    v_dot2_f32_bf16 v146, v132, v132, v146
    v_dot2_f32_bf16 v145, v133, v148, v145
    v_dot2_f32_bf16 v147, v133, v133, v147
    v_dot2_f32_bf16 v144, v134, v148, v144
    v_dot2_f32_bf16 v146, v134, v134, v146
    v_dot2_f32_bf16 v145, v135, v148, v145
    v_dot2_f32_bf16 v147, v135, v135, v147
    v_dot2_f32_bf16 v144, v136, v148, v144
    v_dot2_f32_bf16 v146, v136, v136, v146
    v_dot2_f32_bf16 v145, v137, v148, v145
    v_dot2_f32_bf16 v147, v137, v137, v147
    v_dot2_f32_bf16 v144, v138, v148, v144
    v_dot2_f32_bf16 v146, v138, v138, v146
    v_dot2_f32_bf16 v145, v139, v148, v145
    v_dot2_f32_bf16 v147, v139, v139, v147
    v_dot2_f32_bf16 v144, v140, v148, v144
    v_dot2_f32_bf16 v146, v140, v140, v146
    v_dot2_f32_bf16 v145, v141, v148, v145
    v_dot2_f32_bf16 v147, v141, v141, v147
    v_dot2_f32_bf16 v144, v142, v148, v144
    v_dot2_f32_bf16 v146, v142, v142, v146
    v_dot2_f32_bf16 v145, v143, v148, v145
    v_dot2_f32_bf16 v147, v143, v143, v147
    s_nop 1
    v_add_f32 v30, v144, v145
    v_add_f32 v160, v146, v147
    s_nop 0
    v_add_f32_dpp v30, v30, v30 row_ror:8 row_mask:0xf bank_mask:0xf
    v_add_f32_dpp v160, v160, v160 row_ror:8 row_mask:0xf bank_mask:0xf
    s_nop 0
    v_add_f32_dpp v30, v30, v30 row_ror:4 row_mask:0xf bank_mask:0xf
    v_add_f32_dpp v160, v160, v160 row_ror:4 row_mask:0xf bank_mask:0xf
    s_nop 0
    v_add_f32_dpp v30, v30, v30 row_ror:2 row_mask:0xf bank_mask:0xf
    v_add_f32_dpp v160, v160, v160 row_ror:2 row_mask:0xf bank_mask:0xf
    s_nop 0
    v_add_f32_dpp v30, v30, v30 row_ror:1 row_mask:0xf bank_mask:0xf
    v_add_f32_dpp v160, v160, v160 row_ror:1 row_mask:0xf bank_mask:0xf
    v_mul_f32 v30, 0x3b000000, v30
    v_mul_f32 v160, 0x3b000000, v160
    v_fma_f32 v160, -v30, v30, v160
    v_max_f32 v160, 0, v160
    v_add_f32 v160, 0x3727c5ac, v160
    v_rsq_f32 v160, v160
    ds_bpermute_b32 v30, v162, v30
    ds_bpermute_b32 v160, v162, v160
    s_waitcnt vmcnt(1)
    v_perm_b32 v64, v36, v32, s64
    v_perm_b32 v65, v44, v40, s64
    v_perm_b32 v66, v52, v48, s64
    v_perm_b32 v67, v60, v56, s64
    v_perm_b32 v68, v36, v32, s65
    v_perm_b32 v69, v44, v40, s65
    v_perm_b32 v70, v52, v48, s65
    v_perm_b32 v71, v60, v56, s65
    v_perm_b32 v72, v37, v33, s64
    v_perm_b32 v73, v45, v41, s64
    v_perm_b32 v74, v53, v49, s64
    v_perm_b32 v75, v61, v57, s64
    v_perm_b32 v76, v37, v33, s65
    v_perm_b32 v77, v45, v41, s65
    v_perm_b32 v78, v53, v49, s65
    v_perm_b32 v79, v61, v57, s65
    v_perm_b32 v80, v38, v34, s64
    v_perm_b32 v81, v46, v42, s64
    v_perm_b32 v82, v54, v50, s64
    v_perm_b32 v83, v62, v58, s64
    v_perm_b32 v84, v38, v34, s65
    v_perm_b32 v85, v46, v42, s65
    v_perm_b32 v86, v54, v50, s65
    v_perm_b32 v87, v62, v58, s65
    v_perm_b32 v88, v39, v35, s64
    v_perm_b32 v89, v47, v43, s64
    v_perm_b32 v90, v55, v51, s64
    v_perm_b32 v91, v63, v59, s64
    v_perm_b32 v92, v39, v35, s65
    v_perm_b32 v93, v47, v43, s65
    v_perm_b32 v94, v55, v51, s65
    v_perm_b32 v95, v63, v59, s65
    s_waitcnt vmcnt(0)
    v_mfma_f32_16x16x32_bf16 v[96:99], v[64:67], v[24:27], 0
    v_mfma_f32_16x16x32_bf16 v[100:103], v[68:71], v[24:27], 0
    v_mfma_f32_16x16x32_bf16 v[104:107], v[72:75], v[24:27], 0
    v_mfma_f32_16x16x32_bf16 v[108:111], v[76:79], v[24:27], 0
    v_mfma_f32_16x16x32_bf16 v[112:115], v[80:83], v[24:27], 0
    v_mfma_f32_16x16x32_bf16 v[116:119], v[84:87], v[24:27], 0
    v_mfma_f32_16x16x32_bf16 v[120:123], v[88:91], v[24:27], 0
    v_mfma_f32_16x16x32_bf16 v[124:127], v[92:95], v[24:27], 0
    s_mov_b32 exec_lo, 0x1f001f
    s_mov_b32 exec_hi, 0x1f001f
    ds_write_b128 v29, v[96:99] offset:0
    ds_write_b128 v29, v[100:103] offset:512
    ds_write_b128 v29, v[104:107] offset:1024
    ds_write_b128 v29, v[108:111] offset:1536
    ds_write_b128 v29, v[112:115] offset:2048
    ds_write_b128 v29, v[116:119] offset:2560
    ds_write_b128 v29, v[120:123] offset:3072
    ds_write_b128 v29, v[124:127] offset:3584
    s_mov_b64 exec, -1
    s_waitcnt lgkmcnt(0)
    s_barrier
    s_cmp_ge_u32 s53, 6
    s_cbranch_scc1 L_T_a1done
    ds_read_b128 v[40:43], v163 offset:0
    ds_read_b128 v[56:59], v161 offset:64
    ds_read_b128 v[44:47], v163 offset:4096
    ds_read_b128 v[60:63], v161 offset:4160
    ds_read_b128 v[48:51], v163 offset:8192
    ds_read_b128 v[64:67], v161 offset:8256
    ds_read_b128 v[52:55], v163 offset:12288
    ds_read_b128 v[68:71], v161 offset:12352
    s_waitcnt lgkmcnt(0)
    v_pk_add_f32 v[40:41], v[40:41], v[48:49]
    v_pk_add_f32 v[42:43], v[42:43], v[50:51]
    v_pk_add_f32 v[44:45], v[44:45], v[52:53]
    v_pk_add_f32 v[46:47], v[46:47], v[54:55]
    v_pk_add_f32 v[40:41], v[40:41], v[44:45]
    v_pk_add_f32 v[42:43], v[42:43], v[46:47]
    v_pk_add_f32 v[56:57], v[56:57], v[64:65]
    v_pk_add_f32 v[58:59], v[58:59], v[66:67]
    v_pk_add_f32 v[60:61], v[60:61], v[68:69]
    v_pk_add_f32 v[62:63], v[62:63], v[70:71]
    v_pk_add_f32 v[56:57], v[56:57], v[60:61]
    v_pk_add_f32 v[58:59], v[58:59], v[62:63]
    v_pk_fma_f32 v[40:41], v[56:57], v[30:31], v[40:41] op_sel_hi:[1,0,1] neg_lo:[1,0,0] neg_hi:[1,0,0]
    v_pk_fma_f32 v[42:43], v[58:59], v[30:31], v[42:43] op_sel_hi:[1,0,1] neg_lo:[1,0,0] neg_hi:[1,0,0]
    v_pk_mul_f32 v[40:41], v[40:41], v[160:161] op_sel_hi:[1,0]
    v_pk_mul_f32 v[42:43], v[42:43], v[160:161] op_sel_hi:[1,0]
    v_perm_b32 v72, v40, v5, s68
    v_perm_b32 v73, v41, v5, s69
    v_perm_b32 v74, v42, v5, s70
    v_perm_b32 v75, v43, v5, s71
    buffer_store_dwordx4 v[72:75], v7, s[32:35], s73 offen
    buffer_store_dwordx4 v[72:75], v7, s[32:35], s59 offen sc1
L_T_a1done:
    s_lshr_b32 s55, s54, 5
    s_and_b32 s56, s54, 31
    v_and_b32 v44, 31, v1
    v_lshrrev_b32 v45, 5, v1
    s_cmp_ge_u32 s53, 4
    s_cbranch_scc1 L_T_pvw
    s_mov_b32 s36, s6
    s_and_b32 s37, s7, 0xffff
    s_mov_b32 s38, 0x1000000
    s_mov_b32 s39, 0x20000
    v_lshlrev_b32 v7, 2, v2
    v_xor_b32 v7, v7, v3
    v_lshlrev_b32 v7, 4, v7
    v_lshl_add_u32 v8, v2, 10, v7
    v_xor_b32 v9, 32, v8
    v_xor_b32 v10, 16, v8
    v_xor_b32 v11, 48, v8
    s_lshl_b32 s58, s54, 17
    s_lshl_b32 s59, s53, 15
    s_add_u32 s58, s58, s59
    s_lshl_b32 s59, s53, 13
    buffer_load_dword v5, v6, s[32:35], 0 offen sc1
    s_mov_b32 s76, 0x3e0293ee
    v_lshlrev_b32 v41, 5, v44
    v_add_u32 v41, 131072, v41
    v_and_b32 v46, 3, v1
    v_lshlrev_b32 v46, 2, v46
    v_bfe_u32 v47, v1, 2, 1
    v_lshl_add_u32 v46, v47, 1, v46
    v_bfe_u32 v47, v1, 3, 1
    v_add_u32 v46, v46, v47
    v_xor_b32 v46, v46, v45
    v_lshlrev_b32 v46, 4, v46
    v_lshl_add_u32 v46, v44, 8, v46
    v_xor_b32 v56, 0, v46
    v_xor_b32 v57, 32, v46
    v_xor_b32 v58, 64, v46
    v_xor_b32 v59, 96, v46
    v_xor_b32 v60, 128, v46
    v_xor_b32 v61, 160, v46
    v_xor_b32 v62, 192, v46
    v_xor_b32 v63, 224, v46
    v_add_u32 v48, s59, v56
    v_add_u32 v56, 131072, v56
    v_add_u32 v208, 0x10000, v48
    v_add_u32 v49, s59, v57
    v_add_u32 v57, 131072, v57
    v_add_u32 v209, 0x10000, v49
    v_add_u32 v50, s59, v58
    v_add_u32 v58, 131072, v58
    v_add_u32 v210, 0x10000, v50
    v_add_u32 v51, s59, v59
    v_add_u32 v59, 131072, v59
    v_add_u32 v211, 0x10000, v51
    v_add_u32 v52, s59, v60
    v_add_u32 v60, 131072, v60
    v_add_u32 v212, 0x10000, v52
    v_add_u32 v53, s59, v61
    v_add_u32 v61, 131072, v61
    v_add_u32 v213, 0x10000, v53
    v_add_u32 v54, s59, v62
    v_add_u32 v62, 131072, v62
    v_add_u32 v214, 0x10000, v54
    v_add_u32 v55, s59, v63
    v_add_u32 v63, 131072, v63
    v_add_u32 v215, 0x10000, v55
    v_lshl_add_u32 v42, v45, 2, v41
    s_lshl_b32 s75, s53, 3
    v_add_u32 v42, s75, v42
    v_lshlrev_b32 v24, 4, v1
    s_lshl_b32 s75, s53, 11
    s_add_u32 s75, s75, 133120
    v_add_u32 v24, s75, v24
    s_waitcnt vmcnt(0)
    v_add_u32 v5, 0x9e3779b1, v5
    s_add_u32 s61, s54, 0
    s_and_b32 s61, s61, 3
    s_lshl_b32 s61, s61, 8
    s_add_u32 s61, s61, s58
    s_add_u32 m0, s59, 0
    s_add_u32 s60, s61, 0
    buffer_load_dwordx4 v8, s[36:39], s60 offen nt lds
    s_add_u32 m0, s59, 1024
    s_add_u32 s60, s61, 4096
    buffer_load_dwordx4 v9, s[36:39], s60 offen nt lds
    s_add_u32 m0, s59, 2048
    s_add_u32 s60, s61, 8192
    buffer_load_dwordx4 v10, s[36:39], s60 offen nt lds
    s_add_u32 m0, s59, 3072
    s_add_u32 s60, s61, 12288
    buffer_load_dwordx4 v11, s[36:39], s60 offen nt lds
    s_barrier
    s_barrier
    s_add_u32 s61, s54, 0
    s_and_b32 s61, s61, 3
    s_lshl_b32 s61, s61, 8
    s_add_u32 s61, s61, s58
    s_add_u32 m0, s59, 4096
    s_add_u32 s60, s61, 16384
    buffer_load_dwordx4 v8, s[36:39], s60 offen nt lds
    s_add_u32 m0, s59, 5120
    s_add_u32 s60, s61, 20480
    buffer_load_dwordx4 v9, s[36:39], s60 offen nt lds
    s_add_u32 m0, s59, 6144
    s_add_u32 s60, s61, 24576
    buffer_load_dwordx4 v10, s[36:39], s60 offen nt lds
    s_add_u32 m0, s59, 7168
    s_add_u32 s60, s61, 28672
    buffer_load_dwordx4 v11, s[36:39], s60 offen nt lds
    s_add_u32 s61, s54, 1
    s_and_b32 s61, s61, 3
    s_lshl_b32 s61, s61, 8
    s_add_u32 s61, s61, s58
    s_add_u32 m0, s59, 32768
    s_add_u32 s60, s61, 0
    buffer_load_dwordx4 v8, s[36:39], s60 offen nt lds
    s_add_u32 m0, s59, 33792
    s_add_u32 s60, s61, 4096
    buffer_load_dwordx4 v9, s[36:39], s60 offen nt lds
    s_add_u32 m0, s59, 34816
    s_add_u32 s60, s61, 8192
    buffer_load_dwordx4 v10, s[36:39], s60 offen nt lds
    s_add_u32 m0, s59, 35840
    s_add_u32 s60, s61, 12288
    buffer_load_dwordx4 v11, s[36:39], s60 offen nt lds
    s_add_u32 m0, s59, 36864
    s_add_u32 s60, s61, 16384
    buffer_load_dwordx4 v8, s[36:39], s60 offen nt lds
    s_add_u32 m0, s59, 37888
    s_add_u32 s60, s61, 20480
    buffer_load_dwordx4 v9, s[36:39], s60 offen nt lds
    s_add_u32 m0, s59, 38912
    s_add_u32 s60, s61, 24576
    buffer_load_dwordx4 v10, s[36:39], s60 offen nt lds
    s_add_u32 m0, s59, 39936
    s_add_u32 s60, s61, 28672
    buffer_load_dwordx4 v11, s[36:39], s60 offen nt lds
    s_add_u32 s61, s54, 2
    s_and_b32 s61, s61, 3
    s_lshl_b32 s61, s61, 8
    s_add_u32 s61, s61, s58
    s_add_u32 m0, s59, 65536
    s_add_u32 s60, s61, 0
    buffer_load_dwordx4 v8, s[36:39], s60 offen nt lds
    s_add_u32 m0, s59, 66560
    s_add_u32 s60, s61, 4096
    buffer_load_dwordx4 v9, s[36:39], s60 offen nt lds
    s_add_u32 m0, s59, 67584
    s_add_u32 s60, s61, 8192
    buffer_load_dwordx4 v10, s[36:39], s60 offen nt lds
    s_add_u32 m0, s59, 68608
    s_add_u32 s60, s61, 12288
    buffer_load_dwordx4 v11, s[36:39], s60 offen nt lds
    s_add_u32 m0, s59, 69632
    s_add_u32 s60, s61, 16384
    buffer_load_dwordx4 v8, s[36:39], s60 offen nt lds
    s_add_u32 m0, s59, 70656
    s_add_u32 s60, s61, 20480
    buffer_load_dwordx4 v9, s[36:39], s60 offen nt lds
    s_add_u32 m0, s59, 71680
    s_add_u32 s60, s61, 24576
    buffer_load_dwordx4 v10, s[36:39], s60 offen nt lds
    s_add_u32 m0, s59, 72704
    s_add_u32 s60, s61, 28672
    buffer_load_dwordx4 v11, s[36:39], s60 offen nt lds
    s_add_u32 s61, s54, 3
    s_and_b32 s61, s61, 3
    s_lshl_b32 s61, s61, 8
    s_add_u32 s61, s61, s58
    s_add_u32 m0, s59, 98304
    s_add_u32 s60, s61, 0
    buffer_load_dwordx4 v8, s[36:39], s60 offen nt lds
    s_add_u32 m0, s59, 99328
    s_add_u32 s60, s61, 4096
    buffer_load_dwordx4 v9, s[36:39], s60 offen nt lds
    s_add_u32 m0, s59, 100352
    s_add_u32 s60, s61, 8192
    buffer_load_dwordx4 v10, s[36:39], s60 offen nt lds
    s_add_u32 m0, s59, 101376
    s_add_u32 s60, s61, 12288
    buffer_load_dwordx4 v11, s[36:39], s60 offen nt lds
    s_add_u32 m0, s59, 102400
    s_add_u32 s60, s61, 16384
    buffer_load_dwordx4 v8, s[36:39], s60 offen nt lds
    s_add_u32 m0, s59, 103424
    s_add_u32 s60, s61, 20480
    buffer_load_dwordx4 v9, s[36:39], s60 offen nt lds
    s_add_u32 m0, s59, 104448
    s_add_u32 s60, s61, 24576
    buffer_load_dwordx4 v10, s[36:39], s60 offen nt lds
    s_add_u32 m0, s59, 105472
    s_add_u32 s60, s61, 28672
    buffer_load_dwordx4 v11, s[36:39], s60 offen nt lds
    s_waitcnt vmcnt(8)
    s_barrier
    ds_read_b128 v[80:83], v48 offset:0
    ds_read_b128 v[84:87], v49 offset:0
    ds_read_b128 v[88:91], v50 offset:0
    ds_read_b128 v[92:95], v51 offset:0
    ds_read_b128 v[96:99], v52 offset:0
    ds_read_b128 v[100:103], v53 offset:0
    ds_read_b128 v[104:107], v54 offset:0
    ds_read_b128 v[108:111], v55 offset:0
    ds_read_b128 v[112:115], v48 offset:32768
    ds_read_b128 v[116:119], v49 offset:32768
    ds_read_b128 v[120:123], v50 offset:32768
    ds_read_b128 v[124:127], v51 offset:32768
    ds_read_b128 v[128:131], v52 offset:32768
    ds_read_b128 v[132:135], v53 offset:32768
    ds_read_b128 v[136:139], v54 offset:32768
    ds_read_b128 v[140:143], v55 offset:32768
    s_waitcnt vmcnt(8)
    ds_read_b128 v[144:147], v208 offset:0
    ds_read_b128 v[148:151], v209 offset:0
    ds_read_b128 v[152:155], v210 offset:0
    ds_read_b128 v[156:159], v211 offset:0
    ds_read_b128 v[160:163], v212 offset:0
    ds_read_b128 v[164:167], v213 offset:0
    ds_read_b128 v[168:171], v214 offset:0
    ds_read_b128 v[172:175], v215 offset:0
    s_waitcnt vmcnt(0)
    ds_read_b128 v[176:179], v208 offset:32768
    ds_read_b128 v[180:183], v209 offset:32768
    ds_read_b128 v[184:187], v210 offset:32768
    ds_read_b128 v[188:191], v211 offset:32768
    ds_read_b128 v[192:195], v212 offset:32768
    ds_read_b128 v[196:199], v213 offset:32768
    ds_read_b128 v[200:203], v214 offset:32768
    ds_read_b128 v[204:207], v215 offset:32768
    s_barrier
    ds_read_b128 v[216:219], v56 offset:0
    ds_read_b128 v[220:223], v57 offset:0
    ds_read_b128 v[224:227], v58 offset:0
    ds_read_b128 v[228:231], v59 offset:0
    ds_read_b128 v[232:235], v60 offset:0
    ds_read_b128 v[236:239], v61 offset:0
    ds_read_b128 v[240:243], v62 offset:0
    s_waitcnt lgkmcnt(6)
    v_mfma_f32_32x32x16_bf16 v[64:79], v[80:83], v[216:219], 0
    ds_read_b128 v[244:247], v63 offset:0
    s_waitcnt lgkmcnt(6)
    v_mfma_f32_32x32x16_bf16 v[64:79], v[84:87], v[220:223], v[64:79]
    ds_read_b128 v[216:219], v56 offset:8192
    s_waitcnt lgkmcnt(6)
    v_mfma_f32_32x32x16_bf16 v[64:79], v[88:91], v[224:227], v[64:79]
    ds_read_b128 v[220:223], v57 offset:8192
    s_waitcnt lgkmcnt(6)
    v_mfma_f32_32x32x16_bf16 v[64:79], v[92:95], v[228:231], v[64:79]
    ds_read_b128 v[224:227], v58 offset:8192
    s_waitcnt lgkmcnt(6)
    v_mfma_f32_32x32x16_bf16 v[64:79], v[96:99], v[232:235], v[64:79]
    ds_read_b128 v[228:231], v59 offset:8192
    s_waitcnt lgkmcnt(6)
    v_mfma_f32_32x32x16_bf16 v[64:79], v[100:103], v[236:239], v[64:79]
    ds_read_b128 v[232:235], v60 offset:8192
    s_waitcnt lgkmcnt(6)
    v_mfma_f32_32x32x16_bf16 v[64:79], v[104:107], v[240:243], v[64:79]
    ds_read_b128 v[236:239], v61 offset:8192
    s_waitcnt lgkmcnt(6)
    v_mfma_f32_32x32x16_bf16 v[64:79], v[108:111], v[244:247], v[64:79]
    ds_read_b128 v[240:243], v62 offset:8192
    s_waitcnt lgkmcnt(6)
    v_mfma_f32_32x32x16_bf16 v[64:79], v[112:115], v[216:219], v[64:79]
    ds_read_b128 v[244:247], v63 offset:8192
    s_waitcnt lgkmcnt(6)
    v_mfma_f32_32x32x16_bf16 v[64:79], v[116:119], v[220:223], v[64:79]
    ds_read_b128 v[216:219], v56 offset:16384
    s_waitcnt lgkmcnt(6)
    v_mfma_f32_32x32x16_bf16 v[64:79], v[120:123], v[224:227], v[64:79]
    ds_read_b128 v[220:223], v57 offset:16384
    s_waitcnt lgkmcnt(6)
    v_mfma_f32_32x32x16_bf16 v[64:79], v[124:127], v[228:231], v[64:79]
    ds_read_b128 v[224:227], v58 offset:16384
    s_waitcnt lgkmcnt(6)
    v_mfma_f32_32x32x16_bf16 v[64:79], v[128:131], v[232:235], v[64:79]
    ds_read_b128 v[228:231], v59 offset:16384
    s_waitcnt lgkmcnt(6)
    v_mfma_f32_32x32x16_bf16 v[64:79], v[132:135], v[236:239], v[64:79]
    ds_read_b128 v[232:235], v60 offset:16384
    s_waitcnt lgkmcnt(6)
    v_mfma_f32_32x32x16_bf16 v[64:79], v[136:139], v[240:243], v[64:79]
    ds_read_b128 v[236:239], v61 offset:16384
    s_waitcnt lgkmcnt(6)
    v_mfma_f32_32x32x16_bf16 v[64:79], v[140:143], v[244:247], v[64:79]
    ds_read_b128 v[240:243], v62 offset:16384
    s_waitcnt lgkmcnt(6)
    s_barrier
    v_mfma_f32_32x32x16_bf16 v[64:79], v[144:147], v[216:219], v[64:79]
    ds_read_b128 v[244:247], v63 offset:16384
    s_waitcnt lgkmcnt(6)
    v_mfma_f32_32x32x16_bf16 v[64:79], v[148:151], v[220:223], v[64:79]
    ds_read_b128 v[216:219], v56 offset:24576
    s_waitcnt lgkmcnt(6)
    v_mfma_f32_32x32x16_bf16 v[64:79], v[152:155], v[224:227], v[64:79]
    ds_read_b128 v[220:223], v57 offset:24576
    s_waitcnt lgkmcnt(6)
    v_mfma_f32_32x32x16_bf16 v[64:79], v[156:159], v[228:231], v[64:79]
    ds_read_b128 v[224:227], v58 offset:24576
    s_waitcnt lgkmcnt(6)
    v_mfma_f32_32x32x16_bf16 v[64:79], v[160:163], v[232:235], v[64:79]
    ds_read_b128 v[228:231], v59 offset:24576
    s_waitcnt lgkmcnt(6)
    v_mfma_f32_32x32x16_bf16 v[64:79], v[164:167], v[236:239], v[64:79]
    ds_read_b128 v[232:235], v60 offset:24576
    s_waitcnt lgkmcnt(6)
    v_mfma_f32_32x32x16_bf16 v[64:79], v[168:171], v[240:243], v[64:79]
    ds_read_b128 v[236:239], v61 offset:24576
    s_waitcnt lgkmcnt(6)
    v_mfma_f32_32x32x16_bf16 v[64:79], v[172:175], v[244:247], v[64:79]
    ds_read_b128 v[240:243], v62 offset:24576
    s_waitcnt lgkmcnt(6)
    v_mfma_f32_32x32x16_bf16 v[64:79], v[176:179], v[216:219], v[64:79]
    ds_read_b128 v[244:247], v63 offset:24576
    s_waitcnt lgkmcnt(6)
    v_mfma_f32_32x32x16_bf16 v[64:79], v[180:183], v[220:223], v[64:79]
    s_waitcnt lgkmcnt(5)
    v_mfma_f32_32x32x16_bf16 v[64:79], v[184:187], v[224:227], v[64:79]
    s_waitcnt lgkmcnt(4)
    v_mfma_f32_32x32x16_bf16 v[64:79], v[188:191], v[228:231], v[64:79]
    s_waitcnt lgkmcnt(3)
    v_mfma_f32_32x32x16_bf16 v[64:79], v[192:195], v[232:235], v[64:79]
    s_waitcnt lgkmcnt(2)
    v_mfma_f32_32x32x16_bf16 v[64:79], v[196:199], v[236:239], v[64:79]
    s_waitcnt lgkmcnt(1)
    v_mfma_f32_32x32x16_bf16 v[64:79], v[200:203], v[240:243], v[64:79]
    s_waitcnt lgkmcnt(0)
    v_mfma_f32_32x32x16_bf16 v[64:79], v[204:207], v[244:247], v[64:79]
    s_nop 11
    v_max3_f32 v40, v64, v65, v66
    v_max3_f32 v43, v67, v68, v69
    v_max3_f32 v40, v40, v70, v71
    v_max3_f32 v43, v43, v72, v73
    v_max3_f32 v40, v40, v74, v75
    v_max3_f32 v43, v43, v76, v77
    v_max3_f32 v40, v40, v78, v79
    v_max_f32 v40, v40, v43
    ds_write_b32 v42, v40
    ds_write_b32 v41, v6 offset:12288
    s_waitcnt lgkmcnt(0)
    s_barrier
    ds_read_b128 v[16:19], v41
    ds_read_b128 v[20:23], v41 offset:16
    s_waitcnt lgkmcnt(0)
    v_max3_f32 v40, v16, v17, v18
    v_max3_f32 v43, v19, v20, v21
    v_max3_f32 v40, v40, v22, v23
    v_max_f32 v40, v40, v43
    v_mul_f32 v52, s76, v40
    v_fma_f32 v64, v64, s76, -v52
    v_fma_f32 v65, v65, s76, -v52
    v_fma_f32 v66, v66, s76, -v52
    v_fma_f32 v67, v67, s76, -v52
    v_fma_f32 v68, v68, s76, -v52
    v_fma_f32 v69, v69, s76, -v52
    v_fma_f32 v70, v70, s76, -v52
    v_fma_f32 v71, v71, s76, -v52
    v_fma_f32 v72, v72, s76, -v52
    v_fma_f32 v73, v73, s76, -v52
    v_fma_f32 v74, v74, s76, -v52
    v_fma_f32 v75, v75, s76, -v52
    v_fma_f32 v76, v76, s76, -v52
    v_fma_f32 v77, v77, s76, -v52
    v_fma_f32 v78, v78, s76, -v52
    v_fma_f32 v79, v79, s76, -v52
    v_exp_f32 v64, v64
    v_exp_f32 v65, v65
    v_exp_f32 v66, v66
    v_exp_f32 v67, v67
    v_exp_f32 v68, v68
    v_exp_f32 v69, v69
    v_exp_f32 v70, v70
    v_exp_f32 v71, v71
    v_exp_f32 v72, v72
    v_exp_f32 v73, v73
    v_exp_f32 v74, v74
    v_exp_f32 v75, v75
    v_exp_f32 v76, v76
    v_exp_f32 v77, v77
    v_exp_f32 v78, v78
    v_exp_f32 v79, v79
    v_cvt_pk_bf16_f32 v16, v64, v65
    v_cvt_pk_bf16_f32 v17, v66, v67
    v_cvt_pk_bf16_f32 v18, v68, v69
    v_cvt_pk_bf16_f32 v19, v70, v71
    v_cvt_pk_bf16_f32 v20, v72, v73
    v_cvt_pk_bf16_f32 v21, v74, v75
    v_cvt_pk_bf16_f32 v22, v76, v77
    v_cvt_pk_bf16_f32 v23, v78, v79
    ds_write_b128 v24, v[16:19]
    ds_write_b128 v24, v[20:23] offset:1024
    s_waitcnt lgkmcnt(0)
    s_barrier
    v_pk_add_f32 v[64:65], v[64:65], v[72:73]
    v_pk_add_f32 v[66:67], v[66:67], v[74:75]
    v_pk_add_f32 v[68:69], v[68:69], v[76:77]
    v_pk_add_f32 v[70:71], v[70:71], v[78:79]
    v_pk_add_f32 v[64:65], v[64:65], v[68:69]
    v_pk_add_f32 v[66:67], v[66:67], v[70:71]
    v_pk_add_f32 v[64:65], v[64:65], v[66:67]
    v_add_f32 v43, v64, v65
    ds_write_b32 v42, v43 offset:1024
    s_waitcnt lgkmcnt(0)
    s_barrier
    s_branch L_T_roles
L_T_pvw:
    s_barrier
    v_lshrrev_b32 v45, 5, v1
    v_and_b32 v13, 255, v0
    v_lshlrev_b32 v12, 4, v13
    s_lshl_b32 s74, s54, 12
    s_and_b32 s75, s74, 0x3000
    v_add_u32 v25, s75, v12
    s_addk_i32 s74, 4096
    s_and_b32 s75, s74, 0x3000
    v_add_u32 v26, s75, v12
    s_addk_i32 s74, 4096
    s_and_b32 s75, s74, 0x3000
    v_add_u32 v27, s75, v12
    s_addk_i32 s74, 4096
    s_and_b32 s75, s74, 0x3000
    v_add_u32 v12, s75, v12
    s_addk_i32 s74, 4096
    s_mul_i32 s58, s55, 49152
    s_add_u32 s58, s58, 0x50000
    s_add_u32 s59, s58, 16384
    s_add_u32 s60, s58, 32768
    v_lshrrev_b32 v16, 5, v13
    v_and_b32 v14, 3, v16
    v_lshlrev_b32 v14, 2, v14
    v_lshrrev_b32 v15, 2, v16
    v_lshl_add_u32 v14, v15, 1, v14
    v_and_b32 v15, 7, v13
    v_lshlrev_b32 v15, 1, v15
    v_xor_b32 v14, v14, v15
    v_lshlrev_b32 v14, 4, v14
    v_lshl_add_u32 v14, v16, 8, v14
    v_bfe_u32 v15, v13, 3, 2
    v_subrev_u32 v15, s54, v15
    v_and_b32 v15, 3, v15
    v_lshl_add_u32 v14, v15, 13, v14
    v_add_u32 v14, 131072, v14
    s_mov_b32 s74, s54
    s_and_b32 s75, s74, 3
    s_lshl_b32 s75, s75, 11
    v_add_u32 v34, s75, v14
    s_and_b32 s75, s74, 1
    s_lshl_b32 s75, s75, 4
    v_xor_b32 v34, s75, v34
    s_add_u32 s74, s74, 1
    s_and_b32 s75, s74, 3
    s_lshl_b32 s75, s75, 11
    v_add_u32 v35, s75, v14
    s_and_b32 s75, s74, 1
    s_lshl_b32 s75, s75, 4
    v_xor_b32 v35, s75, v35
    s_add_u32 s74, s74, 1
    s_and_b32 s75, s74, 3
    s_lshl_b32 s75, s75, 11
    v_add_u32 v36, s75, v14
    s_and_b32 s75, s74, 1
    s_lshl_b32 s75, s75, 4
    v_xor_b32 v36, s75, v36
    s_add_u32 s74, s74, 1
    s_and_b32 s75, s74, 3
    s_lshl_b32 s75, s75, 11
    v_add_u32 v37, s75, v14
    s_and_b32 s75, s74, 1
    s_lshl_b32 s75, s75, 4
    v_xor_b32 v37, s75, v37
    s_add_u32 s74, s74, 1
    v_bfe_u32 v30, v1, 2, 2
    v_bfe_u32 v31, v1, 1, 1
    v_bfe_u32 v32, v1, 4, 1
    v_lshl_add_u32 v31, v32, 1, v31
    v_lshl_add_u32 v31, v30, 2, v31
    v_lshlrev_b32 v31, 4, v31
    v_and_b32 v33, 1, v1
    v_lshl_add_u32 v31, v33, 3, v31
    v_lshl_add_u32 v33, v32, 2, v30
    v_lshl_add_u32 v33, v45, 4, v33
    v_lshl_add_u32 v31, v33, 8, v31
    s_and_b32 s75, s53, 3
    s_lshl_b32 s74, s75, 6
    v_xor_b32 v31, s74, v31
    v_xor_b32 v16, 0, v31
    v_add_u32 v20, 0x10000, v16
    v_xor_b32 v17, 16, v31
    v_add_u32 v21, 0x10000, v17
    v_xor_b32 v18, 32, v31
    v_add_u32 v22, 0x10000, v18
    v_xor_b32 v19, 48, v31
    v_add_u32 v23, 0x10000, v19
    v_lshlrev_b32 v24, 10, v45
    v_lshl_add_u32 v24, v32, 9, v24
    v_lshl_add_u32 v24, v3, 4, v24
    v_add_u32 v24, 133120, v24
    v_lshlrev_b32 v33, 17, v2
    v_lshl_add_u32 v33, v3, 4, v33
    s_lshl_b32 s61, s55, 20
    s_lshl_b32 s74, s56, 10
    s_add_u32 s61, s61, s74
    s_lshl_b32 s74, s75, 8
    s_add_u32 s61, s61, s74
    s_add_u32 s61, s61, 0x100000
    s_barrier
    s_mov_b32 s30, 400000
    buffer_load_dwordx4 v[64:67], v25, s[32:35], s58 offen offset:0 sc1
    buffer_load_dwordx4 v[68:71], v25, s[32:35], s59 offen offset:0 sc1
    buffer_load_dwordx4 v[72:75], v25, s[32:35], s60 offen offset:0 sc1
    buffer_load_dwordx4 v[76:79], v26, s[32:35], s58 offen offset:0 sc1
    buffer_load_dwordx4 v[80:83], v26, s[32:35], s59 offen offset:0 sc1
    buffer_load_dwordx4 v[84:87], v26, s[32:35], s60 offen offset:0 sc1
    buffer_load_dwordx4 v[88:91], v27, s[32:35], s58 offen offset:0 sc1
    buffer_load_dwordx4 v[92:95], v27, s[32:35], s59 offen offset:0 sc1
    buffer_load_dwordx4 v[96:99], v27, s[32:35], s60 offen offset:0 sc1
    buffer_load_dwordx4 v[100:103], v12, s[32:35], s58 offen offset:0 sc1
    buffer_load_dwordx4 v[104:107], v12, s[32:35], s59 offen offset:0 sc1
    buffer_load_dwordx4 v[108:111], v12, s[32:35], s60 offen offset:0 sc1
    ds_read_b64_tr_b16 v[128:129], v16 offset:0
    ds_read_b64_tr_b16 v[130:131], v17 offset:2048
    ds_read_b64_tr_b16 v[132:133], v16 offset:8192
    ds_read_b64_tr_b16 v[134:135], v17 offset:10240
    ds_read_b64_tr_b16 v[136:137], v16 offset:16384
    ds_read_b64_tr_b16 v[138:139], v17 offset:18432
    ds_read_b64_tr_b16 v[140:141], v16 offset:24576
    ds_read_b64_tr_b16 v[142:143], v17 offset:26624
    ds_read_b64_tr_b16 v[144:145], v18 offset:0
    ds_read_b64_tr_b16 v[146:147], v19 offset:2048
    ds_read_b64_tr_b16 v[148:149], v18 offset:8192
    ds_read_b64_tr_b16 v[150:151], v19 offset:10240
    ds_read_b64_tr_b16 v[152:153], v18 offset:16384
    ds_read_b64_tr_b16 v[154:155], v19 offset:18432
    ds_read_b64_tr_b16 v[156:157], v18 offset:24576
    ds_read_b64_tr_b16 v[158:159], v19 offset:26624
    ds_read_b64_tr_b16 v[160:161], v16 offset:32768
    ds_read_b64_tr_b16 v[162:163], v17 offset:34816
    ds_read_b64_tr_b16 v[164:165], v16 offset:40960
    ds_read_b64_tr_b16 v[166:167], v17 offset:43008
    ds_read_b64_tr_b16 v[168:169], v16 offset:49152
    ds_read_b64_tr_b16 v[170:171], v17 offset:51200
    ds_read_b64_tr_b16 v[172:173], v16 offset:57344
    ds_read_b64_tr_b16 v[174:175], v17 offset:59392
    ds_read_b64_tr_b16 v[176:177], v18 offset:32768
    ds_read_b64_tr_b16 v[178:179], v19 offset:34816
    ds_read_b64_tr_b16 v[180:181], v18 offset:40960
    ds_read_b64_tr_b16 v[182:183], v19 offset:43008
    ds_read_b64_tr_b16 v[184:185], v18 offset:49152
    ds_read_b64_tr_b16 v[186:187], v19 offset:51200
    ds_read_b64_tr_b16 v[188:189], v18 offset:57344
    ds_read_b64_tr_b16 v[190:191], v19 offset:59392
    s_branch L_pchk_3
L_poll_1:
    buffer_load_dwordx4 v[64:67], v25, s[32:35], s58 offen offset:0 sc1
    buffer_load_dwordx4 v[68:71], v25, s[32:35], s59 offen offset:0 sc1
    buffer_load_dwordx4 v[72:75], v25, s[32:35], s60 offen offset:0 sc1
    buffer_load_dwordx4 v[76:79], v26, s[32:35], s58 offen offset:0 sc1
    buffer_load_dwordx4 v[80:83], v26, s[32:35], s59 offen offset:0 sc1
    buffer_load_dwordx4 v[84:87], v26, s[32:35], s60 offen offset:0 sc1
    buffer_load_dwordx4 v[88:91], v27, s[32:35], s58 offen offset:0 sc1
    buffer_load_dwordx4 v[92:95], v27, s[32:35], s59 offen offset:0 sc1
    buffer_load_dwordx4 v[96:99], v27, s[32:35], s60 offen offset:0 sc1
    buffer_load_dwordx4 v[100:103], v12, s[32:35], s58 offen offset:0 sc1
    buffer_load_dwordx4 v[104:107], v12, s[32:35], s59 offen offset:0 sc1
    buffer_load_dwordx4 v[108:111], v12, s[32:35], s60 offen offset:0 sc1
L_pchk_3:
    s_waitcnt vmcnt(11)
    v_xor_b32 v43, v67, v5
    s_waitcnt vmcnt(10)
    v_bitop3_b32 v43, v43, v71, v5 bitop3:0xf6
    s_waitcnt vmcnt(9)
    v_bitop3_b32 v43, v43, v75, v5 bitop3:0xf6
    s_waitcnt vmcnt(8)
    v_bitop3_b32 v43, v43, v79, v5 bitop3:0xf6
    s_waitcnt vmcnt(7)
    v_bitop3_b32 v43, v43, v83, v5 bitop3:0xf6
    s_waitcnt vmcnt(6)
    v_bitop3_b32 v43, v43, v87, v5 bitop3:0xf6
    s_waitcnt vmcnt(5)
    v_bitop3_b32 v43, v43, v91, v5 bitop3:0xf6
    s_waitcnt vmcnt(4)
    v_bitop3_b32 v43, v43, v95, v5 bitop3:0xf6
    s_waitcnt vmcnt(3)
    v_bitop3_b32 v43, v43, v99, v5 bitop3:0xf6
    s_waitcnt vmcnt(2)
    v_bitop3_b32 v43, v43, v103, v5 bitop3:0xf6
    s_waitcnt vmcnt(1)
    v_bitop3_b32 v43, v43, v107, v5 bitop3:0xf6
    s_waitcnt vmcnt(0)
    v_bitop3_b32 v43, v43, v111, v5 bitop3:0xf6
    v_cmp_ne_u32 vcc, 0, v43
    s_nop 0
    s_and_b64 exec, exec, vcc
    s_cbranch_scc0 L_pdone_2
    s_sub_u32 s30, s30, 1
    s_cbranch_scc0 L_poll_1
L_pdone_2:
    s_mov_b64 exec, -1
    v_mov_b32 v67, v72
    v_mov_b32 v71, v73
    v_xor_b32 v15, 16, v34
    ds_write_b128 v34, v[64:67]
    ds_write_b128 v15, v[68:71]
    v_mov_b32 v79, v84
    v_mov_b32 v83, v85
    v_xor_b32 v15, 16, v35
    ds_write_b128 v35, v[76:79]
    ds_write_b128 v15, v[80:83]
    v_mov_b32 v91, v96
    v_mov_b32 v95, v97
    v_xor_b32 v15, 16, v36
    ds_write_b128 v36, v[88:91]
    ds_write_b128 v15, v[92:95]
    v_mov_b32 v103, v108
    v_mov_b32 v107, v109
    v_xor_b32 v15, 16, v37
    ds_write_b128 v37, v[100:103]
    ds_write_b128 v15, v[104:107]
    s_waitcnt lgkmcnt(0)
    s_barrier
    ds_read_b64_tr_b16 v[192:193], v20 offset:0
    ds_read_b64_tr_b16 v[194:195], v21 offset:2048
    ds_read_b64_tr_b16 v[196:197], v20 offset:8192
    ds_read_b64_tr_b16 v[198:199], v21 offset:10240
    ds_read_b64_tr_b16 v[200:201], v20 offset:16384
    ds_read_b64_tr_b16 v[202:203], v21 offset:18432
    ds_read_b64_tr_b16 v[204:205], v20 offset:24576
    ds_read_b64_tr_b16 v[206:207], v21 offset:26624
    ds_read_b64_tr_b16 v[208:209], v22 offset:0
    ds_read_b64_tr_b16 v[210:211], v23 offset:2048
    ds_read_b64_tr_b16 v[212:213], v22 offset:8192
    ds_read_b64_tr_b16 v[214:215], v23 offset:10240
    ds_read_b64_tr_b16 v[216:217], v22 offset:16384
    ds_read_b64_tr_b16 v[218:219], v23 offset:18432
    ds_read_b64_tr_b16 v[220:221], v22 offset:24576
    ds_read_b64_tr_b16 v[222:223], v23 offset:26624
    s_barrier
    ds_read_b64_tr_b16 v[224:225], v20 offset:32768
    ds_read_b64_tr_b16 v[226:227], v21 offset:34816
    ds_read_b64_tr_b16 v[228:229], v20 offset:40960
    ds_read_b64_tr_b16 v[230:231], v21 offset:43008
    ds_read_b64_tr_b16 v[232:233], v20 offset:49152
    ds_read_b64_tr_b16 v[234:235], v21 offset:51200
    ds_read_b64_tr_b16 v[236:237], v20 offset:57344
    ds_read_b64_tr_b16 v[238:239], v21 offset:59392
    ds_read_b64_tr_b16 v[240:241], v22 offset:32768
    ds_read_b64_tr_b16 v[242:243], v23 offset:34816
    ds_read_b64_tr_b16 v[244:245], v22 offset:40960
    ds_read_b64_tr_b16 v[246:247], v23 offset:43008
    ds_read_b64_tr_b16 v[248:249], v22 offset:49152
    ds_read_b64_tr_b16 v[250:251], v23 offset:51200
    ds_read_b64_tr_b16 v[252:253], v22 offset:57344
    ds_read_b64_tr_b16 v[254:255], v23 offset:59392
    s_barrier
    s_waitcnt lgkmcnt(0)
    s_barrier
    ds_read_b128 v[64:67], v24 offset:0
    ds_read_b128 v[68:71], v24 offset:2048
    ds_read_b128 v[72:75], v24 offset:4096
    ds_read_b128 v[76:79], v24 offset:6144
    ds_read_b128 v[80:83], v24 offset:256
    ds_read_b128 v[84:87], v24 offset:2304
    ds_read_b128 v[88:91], v24 offset:4352
    ds_read_b128 v[92:95], v24 offset:6400
    s_waitcnt lgkmcnt(7)
    v_mfma_f32_16x16x32_bf16 v[96:99], v[64:67], v[128:131], 0
    v_mfma_f32_16x16x32_bf16 v[100:103], v[64:67], v[144:147], 0
    v_mfma_f32_16x16x32_bf16 v[104:107], v[64:67], v[160:163], 0
    v_mfma_f32_16x16x32_bf16 v[108:111], v[64:67], v[176:179], 0
    v_mfma_f32_16x16x32_bf16 v[112:115], v[64:67], v[192:195], 0
    v_mfma_f32_16x16x32_bf16 v[116:119], v[64:67], v[208:211], 0
    v_mfma_f32_16x16x32_bf16 v[120:123], v[64:67], v[224:227], 0
    v_mfma_f32_16x16x32_bf16 v[124:127], v[64:67], v[240:243], 0
    s_waitcnt lgkmcnt(6)
    v_mfma_f32_16x16x32_bf16 v[96:99], v[68:71], v[132:135], v[96:99]
    v_mfma_f32_16x16x32_bf16 v[100:103], v[68:71], v[148:151], v[100:103]
    v_mfma_f32_16x16x32_bf16 v[104:107], v[68:71], v[164:167], v[104:107]
    v_mfma_f32_16x16x32_bf16 v[108:111], v[68:71], v[180:183], v[108:111]
    v_mfma_f32_16x16x32_bf16 v[112:115], v[68:71], v[196:199], v[112:115]
    v_mfma_f32_16x16x32_bf16 v[116:119], v[68:71], v[212:215], v[116:119]
    v_mfma_f32_16x16x32_bf16 v[120:123], v[68:71], v[228:231], v[120:123]
    v_mfma_f32_16x16x32_bf16 v[124:127], v[68:71], v[244:247], v[124:127]
    s_waitcnt lgkmcnt(5)
    v_mfma_f32_16x16x32_bf16 v[96:99], v[72:75], v[136:139], v[96:99]
    v_mfma_f32_16x16x32_bf16 v[100:103], v[72:75], v[152:155], v[100:103]
    v_mfma_f32_16x16x32_bf16 v[104:107], v[72:75], v[168:171], v[104:107]
    v_mfma_f32_16x16x32_bf16 v[108:111], v[72:75], v[184:187], v[108:111]
    v_mfma_f32_16x16x32_bf16 v[112:115], v[72:75], v[200:203], v[112:115]
    v_mfma_f32_16x16x32_bf16 v[116:119], v[72:75], v[216:219], v[116:119]
    v_mfma_f32_16x16x32_bf16 v[120:123], v[72:75], v[232:235], v[120:123]
    v_mfma_f32_16x16x32_bf16 v[124:127], v[72:75], v[248:251], v[124:127]
    s_waitcnt lgkmcnt(4)
    v_mfma_f32_16x16x32_bf16 v[96:99], v[76:79], v[140:143], v[96:99]
    v_mfma_f32_16x16x32_bf16 v[100:103], v[76:79], v[156:159], v[100:103]
    v_mfma_f32_16x16x32_bf16 v[104:107], v[76:79], v[172:175], v[104:107]
    v_mfma_f32_16x16x32_bf16 v[108:111], v[76:79], v[188:191], v[108:111]
    v_mfma_f32_16x16x32_bf16 v[112:115], v[76:79], v[204:207], v[112:115]
    v_mfma_f32_16x16x32_bf16 v[116:119], v[76:79], v[220:223], v[116:119]
    v_mfma_f32_16x16x32_bf16 v[120:123], v[76:79], v[236:239], v[120:123]
    v_mfma_f32_16x16x32_bf16 v[124:127], v[76:79], v[252:255], v[124:127]
    v_mov_b32 v12, v33
    s_barrier
    s_waitcnt lgkmcnt(0)
    v_mfma_f32_16x16x32_bf16 v[16:19], v[80:83], v[128:131], 0
    v_mfma_f32_16x16x32_bf16 v[20:23], v[80:83], v[144:147], 0
    v_mfma_f32_16x16x32_bf16 v[24:27], v[80:83], v[160:163], 0
    v_mfma_f32_16x16x32_bf16 v[28:31], v[80:83], v[176:179], 0
    v_mfma_f32_16x16x32_bf16 v[32:35], v[80:83], v[192:195], 0
    v_mfma_f32_16x16x32_bf16 v[36:39], v[80:83], v[208:211], 0
    v_mfma_f32_16x16x32_bf16 v[40:43], v[80:83], v[224:227], 0
    v_mfma_f32_16x16x32_bf16 v[44:47], v[80:83], v[240:243], 0
    v_cvt_pk_bf16_f32 v48, v96, v100
    v_cvt_pk_bf16_f32 v49, v104, v108
    v_cvt_pk_bf16_f32 v50, v112, v116
    v_cvt_pk_bf16_f32 v51, v120, v124
    buffer_store_dwordx4 v[48:51], v12, s[32:35], s61 offen sc1
    s_add_u32 s61, s61, 32768
    v_mfma_f32_16x16x32_bf16 v[16:19], v[84:87], v[132:135], v[16:19]
    v_mfma_f32_16x16x32_bf16 v[20:23], v[84:87], v[148:151], v[20:23]
    v_mfma_f32_16x16x32_bf16 v[24:27], v[84:87], v[164:167], v[24:27]
    v_mfma_f32_16x16x32_bf16 v[28:31], v[84:87], v[180:183], v[28:31]
    v_mfma_f32_16x16x32_bf16 v[32:35], v[84:87], v[196:199], v[32:35]
    v_mfma_f32_16x16x32_bf16 v[36:39], v[84:87], v[212:215], v[36:39]
    v_mfma_f32_16x16x32_bf16 v[40:43], v[84:87], v[228:231], v[40:43]
    v_mfma_f32_16x16x32_bf16 v[44:47], v[84:87], v[244:247], v[44:47]
    v_cvt_pk_bf16_f32 v52, v97, v101
    v_cvt_pk_bf16_f32 v53, v105, v109
    v_cvt_pk_bf16_f32 v54, v113, v117
    v_cvt_pk_bf16_f32 v55, v121, v125
    buffer_store_dwordx4 v[52:55], v12, s[32:35], s61 offen sc1
    s_add_u32 s61, s61, 32768
    v_mfma_f32_16x16x32_bf16 v[16:19], v[88:91], v[136:139], v[16:19]
    v_mfma_f32_16x16x32_bf16 v[20:23], v[88:91], v[152:155], v[20:23]
    v_mfma_f32_16x16x32_bf16 v[24:27], v[88:91], v[168:171], v[24:27]
    v_mfma_f32_16x16x32_bf16 v[28:31], v[88:91], v[184:187], v[28:31]
    v_mfma_f32_16x16x32_bf16 v[32:35], v[88:91], v[200:203], v[32:35]
    v_mfma_f32_16x16x32_bf16 v[36:39], v[88:91], v[216:219], v[36:39]
    v_mfma_f32_16x16x32_bf16 v[40:43], v[88:91], v[232:235], v[40:43]
    v_mfma_f32_16x16x32_bf16 v[44:47], v[88:91], v[248:251], v[44:47]
    v_cvt_pk_bf16_f32 v56, v98, v102
    v_cvt_pk_bf16_f32 v57, v106, v110
    v_cvt_pk_bf16_f32 v58, v114, v118
    v_cvt_pk_bf16_f32 v59, v122, v126
    buffer_store_dwordx4 v[56:59], v12, s[32:35], s61 offen sc1
    s_add_u32 s61, s61, 32768
    v_mfma_f32_16x16x32_bf16 v[16:19], v[92:95], v[140:143], v[16:19]
    v_mfma_f32_16x16x32_bf16 v[20:23], v[92:95], v[156:159], v[20:23]
    v_mfma_f32_16x16x32_bf16 v[24:27], v[92:95], v[172:175], v[24:27]
    v_mfma_f32_16x16x32_bf16 v[28:31], v[92:95], v[188:191], v[28:31]
    v_mfma_f32_16x16x32_bf16 v[32:35], v[92:95], v[204:207], v[32:35]
    v_mfma_f32_16x16x32_bf16 v[36:39], v[92:95], v[220:223], v[36:39]
    v_mfma_f32_16x16x32_bf16 v[40:43], v[92:95], v[236:239], v[40:43]
    v_mfma_f32_16x16x32_bf16 v[44:47], v[92:95], v[252:255], v[44:47]
    v_cvt_pk_bf16_f32 v60, v99, v103
    v_cvt_pk_bf16_f32 v61, v107, v111
    v_cvt_pk_bf16_f32 v62, v115, v119
    v_cvt_pk_bf16_f32 v63, v123, v127
    buffer_store_dwordx4 v[60:63], v12, s[32:35], s61 offen sc1
    s_add_u32 s61, s61, 425984
    v_cvt_pk_bf16_f32 v96, v16, v20
    v_cvt_pk_bf16_f32 v97, v24, v28
    v_cvt_pk_bf16_f32 v98, v32, v36
    v_cvt_pk_bf16_f32 v99, v40, v44
    buffer_store_dwordx4 v[96:99], v12, s[32:35], s61 offen sc1
    s_add_u32 s61, s61, 32768
    v_cvt_pk_bf16_f32 v100, v17, v21
    v_cvt_pk_bf16_f32 v101, v25, v29
    v_cvt_pk_bf16_f32 v102, v33, v37
    v_cvt_pk_bf16_f32 v103, v41, v45
    buffer_store_dwordx4 v[100:103], v12, s[32:35], s61 offen sc1
    s_add_u32 s61, s61, 32768
    v_cvt_pk_bf16_f32 v104, v18, v22
    v_cvt_pk_bf16_f32 v105, v26, v30
    v_cvt_pk_bf16_f32 v106, v34, v38
    v_cvt_pk_bf16_f32 v107, v42, v46
    buffer_store_dwordx4 v[104:107], v12, s[32:35], s61 offen sc1
    s_add_u32 s61, s61, 32768
    v_cvt_pk_bf16_f32 v108, v19, v23
    v_cvt_pk_bf16_f32 v109, v27, v31
    v_cvt_pk_bf16_f32 v110, v35, v39
    v_cvt_pk_bf16_f32 v111, v43, v47
    buffer_store_dwordx4 v[108:111], v12, s[32:35], s61 offen sc1
    v_and_b32 v44, 31, v1
    v_lshlrev_b32 v41, 5, v44
    v_add_u32 v41, 131072, v41
    ds_read_b128 v[64:67], v41
    ds_read_b128 v[68:71], v41 offset:16
    ds_read_b128 v[72:75], v41 offset:1024
    ds_read_b128 v[76:79], v41 offset:1040
    v_lshlrev_b32 v44, 4, v44
    s_lshl_b32 s74, s54, 9
    s_add_u32 s74, s74, 0xa0000
    v_mov_b32 v42, 143360
    v_mov_b32 v43, 1
    s_waitcnt lgkmcnt(0)
    v_max3_f32 v80, v64, v65, v66
    v_max3_f32 v81, v67, v68, v69
    v_max3_f32 v80, v80, v70, v71
    v_max_f32 v80, v80, v81
    v_mul_f32 v80, 0x3e0293ee, v80
    v_pk_add_f32 v[72:73], v[72:73], v[76:77]
    v_pk_add_f32 v[74:75], v[74:75], v[78:79]
    v_pk_add_f32 v[72:73], v[72:73], v[74:75]
    v_add_f32 v81, v72, v73
    v_mov_b32 v82, 0
    v_mov_b32 v83, v5
    s_mov_b64 exec, 1
    s_waitcnt vmcnt(0)
    ds_add_rtn_u32 v43, v42, v43
    s_waitcnt lgkmcnt(0)
    v_readfirstlane_b32 s58, v43
    s_mov_b64 exec, -1
    s_cmp_lg_u32 s58, 3
    s_cbranch_scc1 L_T_noflag
    s_mov_b32 exec_hi, 0
    buffer_store_dwordx4 v[80:83], v44, s[32:35], s74 offen sc1
    s_mov_b64 exec, -1
L_T_noflag:
L_T_roles:
    s_lshr_b32 s16, s54, 4
    s_and_b32 s17, s54, 15
    s_lshl3_add_u32 s17, s17, s53
    v_and_b32 v8, 31, v1
    v_lshlrev_b32 v8, 4, v8
    v_lshrrev_b32 v9, 5, v1
    v_mul_u32_u24 v7, 3584, v9
    v_add_u32 v7, v7, v8
    s_mul_i32 s31, s16, 448
    s_andn2_b32 s31, s31, 127
    s_mul_i32 s52, s17, 14336
    s_add_u32 s31, s31, s52
    s_add_u32 s52, s31, 7168
    s_mov_b32 s36, s22
    s_and_b32 s37, s23, 0xffff
    s_mov_b32 s38, 0x1c0000
    s_mov_b32 s39, 0x20000
    s_mov_b32 s40, s20
    s_and_b32 s41, s21, 0xffff
    s_mov_b32 s42, 0x1c0000
    s_mov_b32 s43, 0x20000
    v_lshlrev_b32 v8, 4, v1
    s_mul_i32 s16, s16, 229376
    s_min_u32 s17, s17, 111
    s_lshl_b32 s17, s17, 11
    s_add_u32 s16, s16, s17
    s_barrier
    buffer_load_dwordx4 v[128:131], v7, s[40:43], s31 offen
    buffer_load_dwordx4 v[132:135], v7, s[40:43], s52 offen
    buffer_load_dwordx4 v[136:139], v8, s[36:39], s16 offen
    buffer_load_dwordx4 v[140:143], v8, s[36:39], s16 offen offset:1024
    s_and_b32 s58, s54, 3
    s_cmp_lg_u32 s58, 0
    s_cbranch_scc1 L_T_end
    s_lshr_b32 s55, s54, 2
    v_lshrrev_b32 v30, 4, v0
    v_lshlrev_b32 v30, 13, v30
    v_lshl_add_u32 v30, v3, 4, v30
    s_lshl_b32 s58, s55, 8
    s_add_u32 s58, s58, 0x500000
    s_add_u32 s59, s58, 262144
    v_lshlrev_b32 v31, 4, v0
    v_add_u32 v31, 32768, v31
    s_mov_b32 s48, s24
    s_and_b32 s49, s25, 0xffff
    s_mov_b32 s50, 0x1000
    s_mov_b32 s51, 0x20000
    v_lshrrev_b32 v32, 2, v3
    v_and_b32 v33, 3, v3
    v_lshlrev_b32 v34, 10, v32
    v_lshl_add_u32 v34, v33, 5, v34
    s_lshr_b32 s60, s55, 2
    s_and_b32 s61, s55, 3
    s_lshl_b32 s73, s60, 7
    s_lshl_b32 s74, s61, 3
    s_add_u32 s73, s73, s74
    s_cmp_lg_u32 s53, 0
    s_cbranch_scc1 L_F_poll
    buffer_load_dwordx2 v[36:37], v34, s[44:47], s73 offen
    v_lshlrev_b32 v35, 13, v2
    v_lshl_add_u32 v35, v32, 6, v35
    v_lshl_add_u32 v35, v33, 8, v35
    s_lshl_b32 s60, s60, 10
    s_lshl_b32 s61, s61, 4
    s_add_u32 s60, s60, s61
    s_add_u32 s60, s60, 0x80000
    v_lshlrev_b32 v39, 4, v1
    v_add_u32 v39, 32768, v39
    s_add_u32 s61, s60, 32768
    s_mov_b32 s30, 400000
L_poll_4:
    buffer_load_dwordx4 v[84:87], v35, s[32:35], s60 offen offset:0 sc1
    buffer_load_dwordx4 v[92:95], v35, s[32:35], s61 offen offset:0 sc1
L_pchk_6:
    s_waitcnt vmcnt(1)
    v_perm_b32 v24, v85, v84, s66
    v_perm_b32 v25, v87, v86, s67
    v_or_b32 v24, v24, v25
    v_xor_b32 v26, v24, v5
    s_waitcnt vmcnt(0)
    v_perm_b32 v24, v93, v92, s66
    v_perm_b32 v25, v95, v94, s67
    v_or_b32 v24, v24, v25
    v_bitop3_b32 v26, v26, v24, v5 bitop3:0xf6
    v_cmp_ne_u32 vcc, 0, v26
    s_nop 0
    s_and_b64 exec, exec, vcc
    s_cbranch_scc0 L_pdone_5
    s_sub_u32 s30, s30, 1
    s_cbranch_scc0 L_poll_4
L_pdone_5:
    s_mov_b64 exec, -1
    v_pk_add_f32 v[84:85], v[84:85], v[92:93]
    v_pk_add_f32 v[86:87], v[86:87], v[94:95]
    v_lshlrev_b32 v88, 16, v36
    v_and_b32 v89, s72, v36
    v_lshlrev_b32 v90, 16, v37
    v_and_b32 v91, s72, v37
    s_mov_b32 exec_lo, 0xffff
    s_mov_b32 exec_hi, 0x0
    v_pk_add_f32 v[84:85], v[84:85], v[88:89]
    v_pk_add_f32 v[86:87], v[86:87], v[90:91]
    s_mov_b64 exec, -1
L_F_poll:
    s_cmp_ge_u32 s53, 6
    s_cbranch_scc1 L_F_one
    s_mov_b32 s30, 400000
L_poll_7:
    buffer_load_dwordx4 v[40:43], v30, s[32:35], s58 offen offset:0 sc1
    buffer_load_dwordx4 v[44:47], v30, s[32:35], s59 offen offset:0 sc1
L_pchk_9:
    s_waitcnt vmcnt(1)
    v_perm_b32 v24, v41, v40, s66
    v_perm_b32 v25, v43, v42, s67
    v_or_b32 v24, v24, v25
    v_xor_b32 v26, v24, v5
    s_waitcnt vmcnt(0)
    v_perm_b32 v24, v45, v44, s66
    v_perm_b32 v25, v47, v46, s67
    v_or_b32 v24, v24, v25
    v_bitop3_b32 v26, v26, v24, v5 bitop3:0xf6
    v_cmp_ne_u32 vcc, 0, v26
    s_nop 0
    s_and_b64 exec, exec, vcc
    s_cbranch_scc0 L_pdone_8
    s_sub_u32 s30, s30, 1
    s_cbranch_scc0 L_poll_7
L_pdone_8:
    s_mov_b64 exec, -1
    v_pk_add_f32 v[40:41], v[40:41], v[44:45]
    v_pk_add_f32 v[42:43], v[42:43], v[46:47]
    s_branch L_F_wr
L_F_one:
    s_mov_b32 s30, 400000
L_poll_10:
    buffer_load_dwordx4 v[40:43], v30, s[32:35], s58 offen offset:0 sc1
L_pchk_12:
    s_waitcnt vmcnt(0)
    v_perm_b32 v24, v41, v40, s66
    v_perm_b32 v25, v43, v42, s67
    v_or_b32 v24, v24, v25
    v_xor_b32 v26, v24, v5
    v_cmp_ne_u32 vcc, 0, v26
    s_nop 0
    s_and_b64 exec, exec, vcc
    s_cbranch_scc0 L_pdone_11
    s_sub_u32 s30, s30, 1
    s_cbranch_scc0 L_poll_10
L_pdone_11:
    s_mov_b64 exec, -1
L_F_wr:
    ds_write_b128 v31, v[40:43]
    s_waitcnt lgkmcnt(0)
    s_barrier
    s_cmp_lg_u32 s53, 0
    s_cbranch_scc1 L_F_done
    ds_read_b128 v[48:51], v39 offset:0
    ds_read_b128 v[52:55], v39 offset:1024
    ds_read_b128 v[56:59], v39 offset:2048
    ds_read_b128 v[60:63], v39 offset:3072
    ds_read_b128 v[64:67], v39 offset:4096
    ds_read_b128 v[68:71], v39 offset:5120
    ds_read_b128 v[72:75], v39 offset:6144
    ds_read_b128 v[76:79], v39 offset:7168
    s_waitcnt lgkmcnt(0)
    v_pk_add_f32 v[48:49], v[48:49], v[64:65]
    v_pk_add_f32 v[50:51], v[50:51], v[66:67]
    v_pk_add_f32 v[52:53], v[52:53], v[68:69]
    v_pk_add_f32 v[54:55], v[54:55], v[70:71]
    v_pk_add_f32 v[56:57], v[56:57], v[72:73]
    v_pk_add_f32 v[58:59], v[58:59], v[74:75]
    v_pk_add_f32 v[60:61], v[60:61], v[76:77]
    v_pk_add_f32 v[62:63], v[62:63], v[78:79]
    v_pk_add_f32 v[48:49], v[48:49], v[56:57]
    v_pk_add_f32 v[50:51], v[50:51], v[58:59]
    v_pk_add_f32 v[52:53], v[52:53], v[60:61]
    v_pk_add_f32 v[54:55], v[54:55], v[62:63]
    v_pk_add_f32 v[48:49], v[48:49], v[52:53]
    v_pk_add_f32 v[50:51], v[50:51], v[54:55]
    v_pk_add_f32 v[48:49], v[48:49], v[84:85]
    v_pk_add_f32 v[50:51], v[50:51], v[86:87]
    v_mov_b32 v52, v48
    v_mov_b32 v53, v49
    v_mov_b32 v54, v50
    v_mov_b32 v55, v51
    v_permlane32_swap_b32 v48, v52
    v_permlane32_swap_b32 v49, v53
    v_permlane32_swap_b32 v50, v54
    v_permlane32_swap_b32 v51, v55
    v_add_f32 v48, v48, v52
    v_add_f32 v49, v49, v53
    v_add_f32 v50, v50, v54
    v_add_f32 v51, v51, v55
    v_mov_b32 v52, v48
    v_mov_b32 v53, v49
    v_mov_b32 v54, v50
    v_mov_b32 v55, v51
    v_permlane16_swap_b32 v48, v52
    v_permlane16_swap_b32 v49, v53
    v_permlane16_swap_b32 v50, v54
    v_permlane16_swap_b32 v51, v55
    v_add_f32 v48, v48, v52
    v_add_f32 v49, v49, v53
    v_add_f32 v50, v50, v54
    v_add_f32 v51, v51, v55
    v_cvt_pk_bf16_f32 v56, v48, v49
    v_cvt_pk_bf16_f32 v57, v50, v51
    s_mov_b32 exec_lo, 0xffff
    s_mov_b32 exec_hi, 0x0
    buffer_store_dwordx2 v[56:57], v34, s[48:51], s73 offen
    s_cmp_lg_u32 s55, 0
    s_cbranch_scc1 L_F_done
    s_mov_b64 exec, 1
    buffer_store_dword v5, v6, s[32:35], 0 offen sc1
L_F_done:
    s_mov_b64 exec, -1
L_T_end:
    s_endpgm
L_W_qa2:
    v_and_b32 v148, 3, v3
    v_lshrrev_b32 v151, 2, v3
    v_xor_b32 v7, v2, v148
    v_lshl_add_u32 v7, v7, 2, v151
    v_lshlrev_b32 v7, 4, v7
    v_lshl_add_u32 v7, v148, 8, v7
    v_lshl_add_u32 v7, v151, 12, v7
    v_add_u32 v156, s73, v7
    v_xor_b32 v157, 16, v156
    v_xor_b32 v158, 32, v156
    v_xor_b32 v159, 48, v156
    v_lshlrev_b32 v149, 11, v151
    v_lshl_add_u32 v149, v2, 6, v149
    v_lshl_add_u32 v149, v148, 4, v149
    s_lshl_b32 s60, s55, 13
    s_add_u32 s60, s60, 0x1000
    v_mul_u32_u24 v150, 0xc000, v148
    v_lshl_add_u32 v150, v2, 4, v150
    v_lshl_add_u32 v150, v151, 14, v150
    s_lshl_b32 s61, s55, 3
    s_add_u32 s61, s61, s58
    s_lshl_b32 s61, s61, 6
    s_add_u32 s61, s61, 0x50000
    s_waitcnt vmcnt(0)
    v_add_u32 v5, 0x9e3779b1, v5
    ds_read_b128 v[8:11], v156 offset:0
    ds_read_b128 v[12:15], v157 offset:0
    ds_read_b128 v[16:19], v158 offset:0
    ds_read_b128 v[20:23], v159 offset:0
    ds_read_b128 v[24:27], v156 offset:1024
    ds_read_b128 v[28:31], v157 offset:1024
    ds_read_b128 v[32:35], v158 offset:1024
    ds_read_b128 v[36:39], v159 offset:1024
    ds_read_b128 v[40:43], v156 offset:2048
    ds_read_b128 v[44:47], v157 offset:2048
    ds_read_b128 v[48:51], v158 offset:2048
    ds_read_b128 v[52:55], v159 offset:2048
    ds_read_b128 v[56:59], v156 offset:3072
    ds_read_b128 v[60:63], v157 offset:3072
    ds_read_b128 v[64:67], v158 offset:3072
    ds_read_b128 v[68:71], v159 offset:3072
    v_mov_b32 v139, v5
    v_mov_b32 v146, 0
    s_add_u32 s74, s60, 0x600000
    s_mov_b32 s30, 400000
L_poll_13:
    s_and_b32 s75, s30, 31
    s_cmp_eq_u32 s75, 1
    s_cselect_b32 s75, s60, s74
    buffer_load_dwordx4 v[72:75], v149, s[32:35], s75 offen offset:0 sc1
    buffer_load_dwordx4 v[76:79], v149, s[32:35], s75 offen offset:256 sc1
    buffer_load_dwordx4 v[80:83], v149, s[32:35], s75 offen offset:512 sc1
    buffer_load_dwordx4 v[84:87], v149, s[32:35], s75 offen offset:768 sc1
    buffer_load_dwordx4 v[88:91], v149, s[32:35], s75 offen offset:1024 sc1
    buffer_load_dwordx4 v[92:95], v149, s[32:35], s75 offen offset:1280 sc1
    buffer_load_dwordx4 v[96:99], v149, s[32:35], s75 offen offset:1536 sc1
    buffer_load_dwordx4 v[100:103], v149, s[32:35], s75 offen offset:1792 sc1
L_pchk_15:
    s_waitcnt vmcnt(7)
    v_perm_b32 v152, v73, v72, s66
    v_perm_b32 v153, v75, v74, s67
    v_or_b32 v152, v152, v153
    v_xor_b32 v154, v152, v5
    s_waitcnt vmcnt(6)
    v_perm_b32 v152, v77, v76, s66
    v_perm_b32 v153, v79, v78, s67
    v_or_b32 v152, v152, v153
    v_bitop3_b32 v154, v154, v152, v5 bitop3:0xf6
    s_waitcnt vmcnt(5)
    v_perm_b32 v152, v81, v80, s66
    v_perm_b32 v153, v83, v82, s67
    v_or_b32 v152, v152, v153
    v_bitop3_b32 v154, v154, v152, v5 bitop3:0xf6
    s_waitcnt vmcnt(4)
    v_perm_b32 v152, v85, v84, s66
    v_perm_b32 v153, v87, v86, s67
    v_or_b32 v152, v152, v153
    v_bitop3_b32 v154, v154, v152, v5 bitop3:0xf6
    s_waitcnt vmcnt(3)
    v_perm_b32 v152, v89, v88, s66
    v_perm_b32 v153, v91, v90, s67
    v_or_b32 v152, v152, v153
    v_bitop3_b32 v154, v154, v152, v5 bitop3:0xf6
    s_waitcnt vmcnt(2)
    v_perm_b32 v152, v93, v92, s66
    v_perm_b32 v153, v95, v94, s67
    v_or_b32 v152, v152, v153
    v_bitop3_b32 v154, v154, v152, v5 bitop3:0xf6
    s_waitcnt vmcnt(1)
    v_perm_b32 v152, v97, v96, s66
    v_perm_b32 v153, v99, v98, s67
    v_or_b32 v152, v152, v153
    v_bitop3_b32 v154, v154, v152, v5 bitop3:0xf6
    s_waitcnt vmcnt(0)
    v_perm_b32 v152, v101, v100, s66
    v_perm_b32 v153, v103, v102, s67
    v_or_b32 v152, v152, v153
    v_bitop3_b32 v154, v154, v152, v5 bitop3:0xf6
    v_cmp_ne_u32 vcc, 0, v154
    s_nop 0
    s_and_b64 exec, exec, vcc
    s_cbranch_scc0 L_pdone_14
    s_sub_u32 s30, s30, 1
    s_cbranch_scc0 L_poll_13
L_pdone_14:
    s_mov_b64 exec, -1
    v_cvt_pk_bf16_f32 v104, v72, v76
    v_cvt_pk_bf16_f32 v105, v80, v84
    v_cvt_pk_bf16_f32 v106, v88, v92
    v_cvt_pk_bf16_f32 v107, v96, v100
    v_cvt_pk_bf16_f32 v108, v73, v77
    v_cvt_pk_bf16_f32 v109, v81, v85
    v_cvt_pk_bf16_f32 v110, v89, v93
    v_cvt_pk_bf16_f32 v111, v97, v101
    v_cvt_pk_bf16_f32 v112, v74, v78
    v_cvt_pk_bf16_f32 v113, v82, v86
    v_cvt_pk_bf16_f32 v114, v90, v94
    v_cvt_pk_bf16_f32 v115, v98, v102
    v_cvt_pk_bf16_f32 v116, v75, v79
    v_cvt_pk_bf16_f32 v117, v83, v87
    v_cvt_pk_bf16_f32 v118, v91, v95
    v_cvt_pk_bf16_f32 v119, v99, v103
    s_waitcnt lgkmcnt(0)
    v_mfma_f32_16x16x32_bf16 v[120:123], v[8:11], v[104:107], 0
    v_mfma_f32_16x16x32_bf16 v[124:127], v[24:27], v[104:107], 0
    v_mfma_f32_16x16x32_bf16 v[128:131], v[40:43], v[104:107], 0
    v_mfma_f32_16x16x32_bf16 v[132:135], v[56:59], v[104:107], 0
    v_mfma_f32_16x16x32_bf16 v[120:123], v[12:15], v[108:111], v[120:123]
    v_mfma_f32_16x16x32_bf16 v[124:127], v[28:31], v[108:111], v[124:127]
    v_mfma_f32_16x16x32_bf16 v[128:131], v[44:47], v[108:111], v[128:131]
    v_mfma_f32_16x16x32_bf16 v[132:135], v[60:63], v[108:111], v[132:135]
    v_mfma_f32_16x16x32_bf16 v[120:123], v[16:19], v[112:115], v[120:123]
    v_mfma_f32_16x16x32_bf16 v[124:127], v[32:35], v[112:115], v[124:127]
    v_mfma_f32_16x16x32_bf16 v[128:131], v[48:51], v[112:115], v[128:131]
    v_mfma_f32_16x16x32_bf16 v[132:135], v[64:67], v[112:115], v[132:135]
    v_mfma_f32_16x16x32_bf16 v[120:123], v[20:23], v[116:119], v[120:123]
    v_mfma_f32_16x16x32_bf16 v[124:127], v[36:39], v[116:119], v[124:127]
    v_mfma_f32_16x16x32_bf16 v[128:131], v[52:55], v[116:119], v[128:131]
    v_mfma_f32_16x16x32_bf16 v[132:135], v[68:71], v[116:119], v[132:135]
    s_nop 4
    v_add_f32_dpp v120, v120, v120 row_ror:4 row_mask:0xf bank_mask:0xf
    v_add_f32_dpp v121, v121, v121 row_ror:4 row_mask:0xf bank_mask:0xf
    v_add_f32_dpp v122, v122, v122 row_ror:4 row_mask:0xf bank_mask:0xf
    v_add_f32_dpp v123, v123, v123 row_ror:4 row_mask:0xf bank_mask:0xf
    v_add_f32_dpp v124, v124, v124 row_ror:4 row_mask:0xf bank_mask:0xf
    v_add_f32_dpp v125, v125, v125 row_ror:4 row_mask:0xf bank_mask:0xf
    v_add_f32_dpp v126, v126, v126 row_ror:4 row_mask:0xf bank_mask:0xf
    v_add_f32_dpp v127, v127, v127 row_ror:4 row_mask:0xf bank_mask:0xf
    v_add_f32_dpp v128, v128, v128 row_ror:4 row_mask:0xf bank_mask:0xf
    v_add_f32_dpp v129, v129, v129 row_ror:4 row_mask:0xf bank_mask:0xf
    v_add_f32_dpp v130, v130, v130 row_ror:4 row_mask:0xf bank_mask:0xf
    v_add_f32_dpp v131, v131, v131 row_ror:4 row_mask:0xf bank_mask:0xf
    v_add_f32_dpp v132, v132, v132 row_ror:4 row_mask:0xf bank_mask:0xf
    v_add_f32_dpp v133, v133, v133 row_ror:4 row_mask:0xf bank_mask:0xf
    v_add_f32_dpp v134, v134, v134 row_ror:4 row_mask:0xf bank_mask:0xf
    v_add_f32_dpp v135, v135, v135 row_ror:4 row_mask:0xf bank_mask:0xf
    v_add_f32_dpp v120, v120, v120 row_ror:8 row_mask:0xf bank_mask:0xf
    v_add_f32_dpp v121, v121, v121 row_ror:8 row_mask:0xf bank_mask:0xf
    v_add_f32_dpp v122, v122, v122 row_ror:8 row_mask:0xf bank_mask:0xf
    v_add_f32_dpp v123, v123, v123 row_ror:8 row_mask:0xf bank_mask:0xf
    v_add_f32_dpp v124, v124, v124 row_ror:8 row_mask:0xf bank_mask:0xf
    v_add_f32_dpp v125, v125, v125 row_ror:8 row_mask:0xf bank_mask:0xf
    v_add_f32_dpp v126, v126, v126 row_ror:8 row_mask:0xf bank_mask:0xf
    v_add_f32_dpp v127, v127, v127 row_ror:8 row_mask:0xf bank_mask:0xf
    v_add_f32_dpp v128, v128, v128 row_ror:8 row_mask:0xf bank_mask:0xf
    v_add_f32_dpp v129, v129, v129 row_ror:8 row_mask:0xf bank_mask:0xf
    v_add_f32_dpp v130, v130, v130 row_ror:8 row_mask:0xf bank_mask:0xf
    v_add_f32_dpp v131, v131, v131 row_ror:8 row_mask:0xf bank_mask:0xf
    v_add_f32_dpp v132, v132, v132 row_ror:8 row_mask:0xf bank_mask:0xf
    v_add_f32_dpp v133, v133, v133 row_ror:8 row_mask:0xf bank_mask:0xf
    v_add_f32_dpp v134, v134, v134 row_ror:8 row_mask:0xf bank_mask:0xf
    v_add_f32_dpp v135, v135, v135 row_ror:8 row_mask:0xf bank_mask:0xf
    v_cvt_pk_bf16_f32 v136, v120, v121
    v_cvt_pk_bf16_f32 v137, v122, v123
    v_cvt_pk_bf16_f32 v138, v124, v125
    v_cvt_pk_bf16_f32 v144, v126, v127
    v_cvt_pk_bf16_f32 v140, v128, v129
    v_cvt_pk_bf16_f32 v141, v130, v131
    v_cvt_pk_bf16_f32 v142, v132, v133
    v_cvt_pk_bf16_f32 v145, v134, v135
    s_mov_b32 exec_lo, 0xf000f0
    s_mov_b32 exec_hi, 0xf000f0
    v_mov_b32 v136, v140
    v_mov_b32 v137, v141
    v_mov_b32 v138, v142
    s_mov_b32 exec_lo, 0xf000f00
    s_mov_b32 exec_hi, 0xf000f00
    v_mov_b32 v136, v144
    v_mov_b32 v137, v145
    v_mov_b32 v138, v146
    s_mov_b32 exec_lo, 0xfff0fff
    s_mov_b32 exec_hi, 0xfff0fff
    buffer_store_dwordx4 v[136:139], v150, s[32:35], s61 offen sc1
    s_mov_b64 exec, -1
    s_branch L_W_join
L_W_idle:
    buffer_load_dword v5, v6, s[32:35], 0 offen sc1
    s_waitcnt vmcnt(0)
    v_add_u32 v5, 0x9e3779b1, v5
L_W_join:
    s_barrier
    s_mov_b32 s36, s12
    s_and_b32 s37, s13, 0xffff
    s_mov_b32 s38, 0x400000
    s_mov_b32 s39, 0x20000
    v_lshlrev_b32 v7, 13, v2
    v_lshl_add_u32 v7, v3, 4, v7
    s_and_b32 s60, s56, 1
    s_lshr_b32 s58, s53, 2
    s_lshl1_add_u32 s58, s60, s58
    s_lshl_b32 s58, s58, 18
    s_and_b32 s59, s53, 3
    s_lshl_b32 s59, s59, 15
    s_add_u32 s58, s58, s59
    s_lshl_b32 s59, s55, 8
    s_add_u32 s58, s58, s59
    s_add_u32 s59, s58, 0
    buffer_load_dwordx4 v[8:11], v7, s[36:39], s59 offen nt
    s_add_u32 s59, s58, 131072
    buffer_load_dwordx4 v[12:15], v7, s[36:39], s59 offen nt
    s_add_u32 s59, s58, 1048576
    buffer_load_dwordx4 v[16:19], v7, s[36:39], s59 offen nt
    s_add_u32 s59, s58, 1179648
    buffer_load_dwordx4 v[20:23], v7, s[36:39], s59 offen nt
    s_add_u32 s59, s58, 2097152
    buffer_load_dwordx4 v[24:27], v7, s[36:39], s59 offen nt
    s_add_u32 s59, s58, 2228224
    buffer_load_dwordx4 v[28:31], v7, s[36:39], s59 offen nt
    s_add_u32 s59, s58, 3145728
    buffer_load_dwordx4 v[32:35], v7, s[36:39], s59 offen nt
    s_add_u32 s59, s58, 3276800
    buffer_load_dwordx4 v[36:39], v7, s[36:39], s59 offen nt
    v_and_b32 v148, 31, v1
    v_lshlrev_b32 v148, 4, v148
    v_lshrrev_b32 v149, 5, v1
    v_lshl_add_u32 v150, v149, 20, v148
    s_lshr_b32 s73, s56, 1
    s_lshl_b32 s58, s73, 21
    s_lshl_b32 s59, s55, 15
    s_add_u32 s58, s58, s59
    s_lshl_b32 s59, s53, 12
    s_add_u32 s58, s58, s59
    s_and_b32 s60, s56, 1
    s_lshl_b32 s59, s60, 9
    s_add_u32 s58, s58, s59
    s_add_u32 s61, s58, 0x100000
    v_bfe_u32 v151, v1, 2, 1
    v_lshlrev_b32 v147, 5, v151
    v_and_b32 v151, 3, v1
    v_add_u32 v147, v147, v151
    v_lshlrev_b32 v151, 9, v147
    s_lshl_b32 s58, s73, 15
    s_lshl_b32 s59, s55, 4
    s_add_u32 s58, s58, s59
    s_lshl_b32 s59, s53, 11
    s_add_u32 s58, s58, s59
    s_add_u32 s74, s58, 0xa0000
    v_lshlrev_b32 v147, 3, v147
    s_lshl_b32 s59, s53, 5
    s_add_u32 s59, s59, 12288
    v_add_u32 v147, s59, v147
    v_lshlrev_b32 v143, 3, v1
    v_add_u32 v143, 12288, v143
    v_lshlrev_b32 v152, 7, v149
    s_lshl_b32 s58, s53, 4
    v_add_u32 v152, s58, v152
    v_mul_u32_u24 v153, 4608, v149
    v_add_u32 v153, v153, v148
    s_mul_i32 s58, s53, 576
    v_add_u32 v153, s58, v153
    v_mul_u32_u24 v154, 576, v3
    v_lshl_add_u32 v154, v2, 4, v154
    s_lshl_b32 s58, s53, 6
    v_add_u32 v154, s58, v154
    v_lshlrev_b32 v155, 13, v149
    v_and_b32 v156, 1, v2
    v_lshl_add_u32 v155, v156, 9, v155
    v_lshl_add_u32 v155, v3, 4, v155
    s_lshl_b32 s58, s53, 10
    s_add_u32 s58, s58, 16384
    v_add_u32 v155, s58, v155
    v_bfe_u32 v156, v1, 2, 1
    v_lshlrev_b32 v156, 13, v156
    v_lshl_add_u32 v156, v149, 12, v156
    v_bfe_u32 v157, v1, 3, 2
    v_lshl_add_u32 v156, v157, 6, v156
    v_and_b32 v157, 3, v1
    v_lshl_add_u32 v156, v157, 4, v156
    s_lshl_b32 s58, s53, 8
    s_add_u32 s58, s58, 16384
    v_add_u32 v156, s58, v156
    s_lshl_b32 s75, s55, 12
    s_lshl_b32 s58, s60, 11
    s_add_u32 s75, s75, s58
    s_lshl_b32 s58, s73, 10
    s_add_u32 s75, s75, s58
    s_lshl_b32 s58, s53, 9
    s_add_u32 s75, s75, s58
    s_add_u32 s75, s75, 0xb0000
    v_lshlrev_b32 v7, 10, v2
    v_lshl_add_u32 v7, v3, 4, v7
    buffer_load_dwordx4 v[80:83], v7, s[44:47], 0 offen offset:0
    buffer_load_dwordx4 v[84:87], v7, s[44:47], 0 offen offset:256
    buffer_load_dwordx4 v[88:91], v7, s[44:47], 0 offen offset:512
    buffer_load_dwordx4 v[92:95], v7, s[44:47], 0 offen offset:768
    v_lshrrev_b32 v132, 2, v3
    v_and_b32 v133, 3, v3
    v_lshlrev_b32 v134, 10, v132
    v_lshl_add_u32 v134, v2, 6, v134
    v_lshl_add_u32 v134, v133, 3, v134
    s_and_b32 s31, s53, 3
    s_lshl_b32 s31, s31, 8
    buffer_load_dwordx2 v[136:137], v134, s[44:47], s31 offen offset:0
    buffer_load_dwordx2 v[138:139], v134, s[44:47], s31 offen offset:32
    v_lshlrev_b32 v132, 6, v132
    s_waitcnt vmcnt(0)
    v_mov_b32 v100, 0x3f803f80
    v_dot2_f32_bf16 v96, v80, v100, 0
    v_dot2_f32_bf16 v97, v81, v100, 0
    v_dot2_f32_bf16 v96, v82, v100, v96
    v_dot2_f32_bf16 v97, v83, v100, v97
    v_dot2_f32_bf16 v96, v84, v100, v96
    v_dot2_f32_bf16 v97, v85, v100, v97
    v_dot2_f32_bf16 v96, v86, v100, v96
    v_dot2_f32_bf16 v97, v87, v100, v97
    v_dot2_f32_bf16 v96, v88, v100, v96
    v_dot2_f32_bf16 v97, v89, v100, v97
    v_dot2_f32_bf16 v96, v90, v100, v96
    v_dot2_f32_bf16 v97, v91, v100, v97
    v_dot2_f32_bf16 v96, v92, v100, v96
    v_dot2_f32_bf16 v97, v93, v100, v97
    v_dot2_f32_bf16 v96, v94, v100, v96
    v_dot2_f32_bf16 v97, v95, v100, v97
    s_nop 2
    v_add_f32 v128, v96, v97
    s_nop 1
    v_add_f32_dpp v128, v128, v128 row_ror:8 row_mask:0xf bank_mask:0xf
    s_nop 1
    v_add_f32_dpp v128, v128, v128 row_ror:4 row_mask:0xf bank_mask:0xf
    s_nop 1
    v_add_f32_dpp v128, v128, v128 row_ror:2 row_mask:0xf bank_mask:0xf
    s_nop 1
    v_add_f32_dpp v128, v128, v128 row_ror:1 row_mask:0xf bank_mask:0xf
    v_mul_f32 v128, 0x3b000000, v128
    ds_bpermute_b32 v128, v132, v128
    v_lshlrev_b32 v244, 16, v136
    v_and_b32 v245, s72, v136
    v_lshlrev_b32 v246, 16, v137
    v_and_b32 v247, s72, v137
    v_lshlrev_b32 v248, 16, v138
    v_and_b32 v249, s72, v138
    v_lshlrev_b32 v250, 16, v139
    v_and_b32 v251, s72, v139
    s_waitcnt lgkmcnt(0)
    v_sub_f32 v244, v244, v128
    v_sub_f32 v245, v245, v128
    v_sub_f32 v246, v246, v128
    v_sub_f32 v247, v247, v128
    v_sub_f32 v248, v248, v128
    v_sub_f32 v249, v249, v128
    v_sub_f32 v250, v250, v128
    v_sub_f32 v251, v251, v128
    s_and_b32 s16, s54, 15
    s_cmp_ge_u32 s16, 8
    s_cbranch_scc1 L_dd_skip
    s_lshr_b32 s17, s54, 4
    s_mov_b32 s40, s14
    s_and_b32 s41, s15, 0xffff
    s_mov_b32 s42, 0x400000
    s_mov_b32 s43, 0x20000
    s_lshl_b32 s31, s17, 19
    s_lshl_b32 s52, s53, 16
    s_add_u32 s31, s31, s52
    s_lshl_b32 s52, s16, 7
    s_add_u32 s31, s31, s52
    v_lshrrev_b32 v160, 3, v1
    v_lshlrev_b32 v160, 10, v160
    v_and_b32 v161, 7, v1
    v_lshl_add_u32 v160, v161, 4, v160
    v_bfe_u32 v161, v1, 4, 1
    v_lshlrev_b32 v161, 5, v161
    v_xor_b32 v160, v160, v161
    v_xor_b32 v161, 64, v160
    s_lshl_b32 s52, s53, 13
    s_add_u32 s52, s52, 65536
    s_add_u32 m0, s52, 0
    s_nop 0
    buffer_load_dwordx4 v160, s[40:43], s31 offen nt lds
    s_addk_i32 s31, 8192
    s_add_u32 m0, s52, 1024
    s_nop 0
    buffer_load_dwordx4 v160, s[40:43], s31 offen nt lds
    s_addk_i32 s31, 8192
    s_add_u32 m0, s52, 2048
    s_nop 0
    buffer_load_dwordx4 v160, s[40:43], s31 offen nt lds
    s_addk_i32 s31, 8192
    s_add_u32 m0, s52, 3072
    s_nop 0
    buffer_load_dwordx4 v160, s[40:43], s31 offen nt lds
    s_addk_i32 s31, 8192
    s_add_u32 m0, s52, 4096
    s_nop 0
    buffer_load_dwordx4 v161, s[40:43], s31 offen nt lds
    s_addk_i32 s31, 8192
    s_add_u32 m0, s52, 5120
    s_nop 0
    buffer_load_dwordx4 v161, s[40:43], s31 offen nt lds
    s_addk_i32 s31, 8192
    s_add_u32 m0, s52, 6144
    s_nop 0
    buffer_load_dwordx4 v161, s[40:43], s31 offen nt lds
    s_addk_i32 s31, 8192
    s_add_u32 m0, s52, 7168
    s_nop 0
    buffer_load_dwordx4 v161, s[40:43], s31 offen nt lds
    s_addk_i32 s31, 8192
L_dd_skip:
    s_cmp_lt_u32 s16, 8
    s_cbranch_scc1 L_ed_skip
    s_cmp_eq_u32 s16, 15
    s_cbranch_scc1 L_ed_skip
    s_and_b32 s16, s54, 15
    s_lshr_b32 s17, s54, 4
    s_mov_b32 s40, s18
    s_and_b32 s41, s19, 0xffff
    s_mov_b32 s42, 0x1c0000
    s_mov_b32 s43, 0x20000
    s_mul_i32 s17, s17, 7
    s_add_u32 s17, s17, s16
    s_sub_u32 s17, s17, 8
    s_mul_i32 s31, s53, 229376
    s_lshl_b32 s52, s17, 6
    s_add_u32 s31, s31, s52
    v_lshrrev_b32 v160, 2, v1
    v_mul_u32_u24 v160, 3584, v160
    v_and_b32 v161, 3, v1
    v_lshl_add_u32 v160, v161, 4, v160
    v_xor_b32 v161, 32, v160
    s_lshl_b32 s52, s53, 12
    s_add_u32 s52, s52, 65536
    s_add_u32 m0, s52, 0
    s_nop 0
    buffer_load_dwordx4 v160, s[40:43], s31 offen nt lds
    s_add_u32 s31, s31, 57344
    s_add_u32 m0, s52, 1024
    s_nop 0
    buffer_load_dwordx4 v160, s[40:43], s31 offen nt lds
    s_add_u32 s31, s31, 57344
    s_add_u32 m0, s52, 2048
    s_nop 0
    buffer_load_dwordx4 v161, s[40:43], s31 offen nt lds
    s_add_u32 s31, s31, 57344
    s_add_u32 m0, s52, 3072
    s_nop 0
    buffer_load_dwordx4 v161, s[40:43], s31 offen nt lds
    s_add_u32 s31, s31, 57344
L_ed_skip:
    v_perm_b32 v40, v12, v8, s64
    v_perm_b32 v41, v20, v16, s64
    v_perm_b32 v42, v28, v24, s64
    v_perm_b32 v43, v36, v32, s64
    v_perm_b32 v44, v12, v8, s65
    v_perm_b32 v45, v20, v16, s65
    v_perm_b32 v46, v28, v24, s65
    v_perm_b32 v47, v36, v32, s65
    v_perm_b32 v48, v13, v9, s64
    v_perm_b32 v49, v21, v17, s64
    v_perm_b32 v50, v29, v25, s64
    v_perm_b32 v51, v37, v33, s64
    v_perm_b32 v52, v13, v9, s65
    v_perm_b32 v53, v21, v17, s65
    v_perm_b32 v54, v29, v25, s65
    v_perm_b32 v55, v37, v33, s65
    v_perm_b32 v56, v14, v10, s64
    v_perm_b32 v57, v22, v18, s64
    v_perm_b32 v58, v30, v26, s64
    v_perm_b32 v59, v38, v34, s64
    v_perm_b32 v60, v14, v10, s65
    v_perm_b32 v61, v22, v18, s65
    v_perm_b32 v62, v30, v26, s65
    v_perm_b32 v63, v38, v34, s65
    v_perm_b32 v64, v15, v11, s64
    v_perm_b32 v65, v23, v19, s64
    v_perm_b32 v66, v31, v27, s64
    v_perm_b32 v67, v39, v35, s64
    v_perm_b32 v68, v15, v11, s65
    v_perm_b32 v69, v23, v19, s65
    v_perm_b32 v70, v31, v27, s65
    v_perm_b32 v71, v39, v35, s65
    s_cmp_ge_u32 s53, 2
    s_cbranch_scc1 L_C_nopw
    v_not_b32 v16, v5
    v_not_b32 v17, v5
    v_not_b32 v18, v5
    v_not_b32 v19, v5
    s_add_u32 s58, s75, 0x600000
    s_mov_b32 exec_hi, 0
    buffer_store_dwordx4 v[16:19], v148, s[32:35], s58 offen
    s_mov_b64 exec, -1
L_C_nopw:
    s_waitcnt vmcnt(0)
    s_barrier
    s_mov_b64 exec, 0xff
    s_mov_b32 s30, 400000
L_poll_16:
    buffer_load_dwordx4 v[88:91], v151, s[32:35], s74 offen offset:0 sc1
L_pchk_18:
    s_waitcnt vmcnt(0)
    v_xor_b32 v146, v91, v5
    v_cmp_ne_u32 vcc, 0, v146
    s_nop 0
    s_and_b64 exec, exec, vcc
    s_cbranch_scc0 L_pdone_17
    s_sub_u32 s30, s30, 1
    s_cbranch_scc0 L_poll_16
L_pdone_17:
    s_mov_b64 exec, -1
    buffer_load_dwordx4 v[72:75], v150, s[32:35], s61 offen offset:0 sc1
    buffer_load_dwordx4 v[76:79], v150, s[32:35], s61 offen offset:1024 sc1
    buffer_load_dwordx4 v[80:83], v150, s[32:35], s61 offen offset:2048 sc1
    buffer_load_dwordx4 v[84:87], v150, s[32:35], s61 offen offset:3072 sc1
    s_mov_b64 exec, 0xff
    ds_write_b64 v147, v[88:89]
    s_mov_b64 exec, -1
    s_waitcnt lgkmcnt(0)
    s_barrier
    ds_read_b64 v[88:89], v143
    s_waitcnt lgkmcnt(0)
    v_mov_b32 v144, v88
    s_nop 1
    v_max_f32_dpp v144, v144, v144 row_ror:8 row_mask:0xf bank_mask:0xf
    s_nop 1
    v_max_f32_dpp v144, v144, v144 row_ror:4 row_mask:0xf bank_mask:0xf
    s_nop 1
    v_max_f32_dpp v144, v144, v144 row_ror:2 row_mask:0xf bank_mask:0xf
    s_nop 1
    v_max_f32_dpp v144, v144, v144 row_ror:1 row_mask:0xf bank_mask:0xf
    v_mov_b32 v145, v144
    s_nop 1
    v_permlane16_swap_b32 v144, v145
    v_max_f32 v144, v144, v145
    v_sub_f32 v146, v88, v144
    v_exp_f32 v146, v146
    s_nop 0
    v_mul_f32 v144, v146, v89
    s_nop 1
    v_add_f32_dpp v144, v144, v144 row_ror:8 row_mask:0xf bank_mask:0xf
    s_nop 1
    v_add_f32_dpp v144, v144, v144 row_ror:4 row_mask:0xf bank_mask:0xf
    s_nop 1
    v_add_f32_dpp v144, v144, v144 row_ror:2 row_mask:0xf bank_mask:0xf
    s_nop 1
    v_add_f32_dpp v144, v144, v144 row_ror:1 row_mask:0xf bank_mask:0xf
    v_mov_b32 v145, v144
    s_nop 1
    v_permlane16_swap_b32 v144, v145
    v_add_f32 v144, v144, v145
    v_rcp_f32 v144, v144
    s_nop 0
    v_mul_f32 v146, v146, v144
    ds_bpermute_b32 v136, v152, v146 offset:0
    ds_bpermute_b32 v138, v152, v146 offset:4
    ds_bpermute_b32 v140, v152, v146 offset:8
    ds_bpermute_b32 v142, v152, v146 offset:12
    s_waitcnt lgkmcnt(0)
    s_waitcnt vmcnt(3)
    v_lshlrev_b32 v96, 16, v72
    v_and_b32 v97, s72, v72
    v_pk_mul_f32 v[96:97], v[96:97], v[136:137] op_sel_hi:[1,0]
    v_lshlrev_b32 v98, 16, v73
    v_and_b32 v99, s72, v73
    v_pk_mul_f32 v[98:99], v[98:99], v[136:137] op_sel_hi:[1,0]
    v_lshlrev_b32 v100, 16, v74
    v_and_b32 v101, s72, v74
    v_pk_mul_f32 v[100:101], v[100:101], v[136:137] op_sel_hi:[1,0]
    v_lshlrev_b32 v102, 16, v75
    v_and_b32 v103, s72, v75
    v_pk_mul_f32 v[102:103], v[102:103], v[136:137] op_sel_hi:[1,0]
    s_waitcnt vmcnt(2)
    v_lshlrev_b32 v128, 16, v76
    v_and_b32 v129, s72, v76
    v_pk_fma_f32 v[98:99], v[128:129], v[138:139], v[98:99] op_sel_hi:[1,0,1]
    v_lshlrev_b32 v130, 16, v77
    v_and_b32 v131, s72, v77
    v_pk_fma_f32 v[100:101], v[130:131], v[138:139], v[100:101] op_sel_hi:[1,0,1]
    v_lshlrev_b32 v128, 16, v78
    v_and_b32 v129, s72, v78
    v_pk_fma_f32 v[102:103], v[128:129], v[138:139], v[102:103] op_sel_hi:[1,0,1]
    v_lshlrev_b32 v130, 16, v79
    v_and_b32 v131, s72, v79
    v_pk_fma_f32 v[96:97], v[130:131], v[138:139], v[96:97] op_sel_hi:[1,0,1]
    s_waitcnt vmcnt(1)
    v_lshlrev_b32 v128, 16, v80
    v_and_b32 v129, s72, v80
    v_pk_fma_f32 v[100:101], v[128:129], v[140:141], v[100:101] op_sel_hi:[1,0,1]
    v_lshlrev_b32 v130, 16, v81
    v_and_b32 v131, s72, v81
    v_pk_fma_f32 v[102:103], v[130:131], v[140:141], v[102:103] op_sel_hi:[1,0,1]
    v_lshlrev_b32 v128, 16, v82
    v_and_b32 v129, s72, v82
    v_pk_fma_f32 v[96:97], v[128:129], v[140:141], v[96:97] op_sel_hi:[1,0,1]
    v_lshlrev_b32 v130, 16, v83
    v_and_b32 v131, s72, v83
    v_pk_fma_f32 v[98:99], v[130:131], v[140:141], v[98:99] op_sel_hi:[1,0,1]
    s_waitcnt vmcnt(0)
    v_lshlrev_b32 v128, 16, v84
    v_and_b32 v129, s72, v84
    v_pk_fma_f32 v[102:103], v[128:129], v[142:143], v[102:103] op_sel_hi:[1,0,1]
    v_lshlrev_b32 v130, 16, v85
    v_and_b32 v131, s72, v85
    v_pk_fma_f32 v[96:97], v[130:131], v[142:143], v[96:97] op_sel_hi:[1,0,1]
    v_lshlrev_b32 v128, 16, v86
    v_and_b32 v129, s72, v86
    v_pk_fma_f32 v[98:99], v[128:129], v[142:143], v[98:99] op_sel_hi:[1,0,1]
    v_lshlrev_b32 v130, 16, v87
    v_and_b32 v131, s72, v87
    v_pk_fma_f32 v[100:101], v[130:131], v[142:143], v[100:101] op_sel_hi:[1,0,1]
    v_cvt_pk_bf16_f32 v132, v96, v97
    v_cvt_pk_bf16_f32 v133, v98, v99
    v_cvt_pk_bf16_f32 v134, v100, v101
    v_cvt_pk_bf16_f32 v135, v102, v103
    ds_write_b128 v153, v[132:135]
    s_waitcnt lgkmcnt(0)
    s_barrier
    ds_read_b128 v[132:135], v154
    s_waitcnt lgkmcnt(0)
    v_mfma_f32_16x16x32_bf16 v[96:99], v[132:135], v[40:43], 0
    v_mfma_f32_16x16x32_bf16 v[100:103], v[132:135], v[44:47], 0
    v_mfma_f32_16x16x32_bf16 v[104:107], v[132:135], v[48:51], 0
    v_mfma_f32_16x16x32_bf16 v[108:111], v[132:135], v[52:55], 0
    v_mfma_f32_16x16x32_bf16 v[112:115], v[132:135], v[56:59], 0
    v_mfma_f32_16x16x32_bf16 v[116:119], v[132:135], v[60:63], 0
    v_mfma_f32_16x16x32_bf16 v[120:123], v[132:135], v[64:67], 0
    v_mfma_f32_16x16x32_bf16 v[124:127], v[132:135], v[68:71], 0
    s_nop 0
    v_pk_add_f32 v[96:97], v[96:97], v[98:99]
    v_pk_add_f32 v[100:101], v[100:101], v[102:103]
    v_pk_add_f32 v[104:105], v[104:105], v[106:107]
    v_pk_add_f32 v[108:109], v[108:109], v[110:111]
    v_pk_add_f32 v[112:113], v[112:113], v[114:115]
    v_pk_add_f32 v[116:117], v[116:117], v[118:119]
    v_pk_add_f32 v[120:121], v[120:121], v[122:123]
    v_pk_add_f32 v[124:125], v[124:125], v[126:127]
    v_add_f32 v72, v96, v97
    v_add_f32 v73, v100, v101
    v_add_f32 v74, v104, v105
    v_add_f32 v75, v108, v109
    v_add_f32 v76, v112, v113
    v_add_f32 v77, v116, v117
    v_add_f32 v78, v120, v121
    v_add_f32 v79, v124, v125
    ds_write_b128 v155, v[72:75]
    ds_write_b128 v155, v[76:79] offset:256
    s_waitcnt lgkmcnt(0)
    s_barrier
    s_cmp_ge_u32 s53, 2
    s_cbranch_scc1 L_C_done
    ds_read_b128 v[8:11], v156 offset:0
    ds_read_b128 v[12:15], v156 offset:512
    ds_read_b128 v[16:19], v156 offset:1024
    ds_read_b128 v[20:23], v156 offset:1536
    ds_read_b128 v[24:27], v156 offset:2048
    ds_read_b128 v[28:31], v156 offset:2560
    ds_read_b128 v[32:35], v156 offset:3072
    ds_read_b128 v[36:39], v156 offset:3584
    s_waitcnt lgkmcnt(0)
    v_pk_add_f32 v[8:9], v[8:9], v[24:25]
    v_pk_add_f32 v[10:11], v[10:11], v[26:27]
    v_pk_add_f32 v[12:13], v[12:13], v[28:29]
    v_pk_add_f32 v[14:15], v[14:15], v[30:31]
    v_pk_add_f32 v[16:17], v[16:17], v[32:33]
    v_pk_add_f32 v[18:19], v[18:19], v[34:35]
    v_pk_add_f32 v[20:21], v[20:21], v[36:37]
    v_pk_add_f32 v[22:23], v[22:23], v[38:39]
    v_pk_add_f32 v[8:9], v[8:9], v[16:17]
    v_pk_add_f32 v[10:11], v[10:11], v[18:19]
    v_pk_add_f32 v[12:13], v[12:13], v[20:21]
    v_pk_add_f32 v[14:15], v[14:15], v[22:23]
    v_pk_add_f32 v[8:9], v[8:9], v[12:13]
    v_pk_add_f32 v[10:11], v[10:11], v[14:15]
    v_mov_b32 v12, v8
    v_mov_b32 v13, v9
    v_mov_b32 v14, v10
    v_mov_b32 v15, v11
    v_permlane32_swap_b32 v8, v12
    v_permlane32_swap_b32 v9, v13
    v_permlane32_swap_b32 v10, v14
    v_permlane32_swap_b32 v11, v15
    v_add_f32 v8, v8, v12
    v_add_f32 v9, v9, v13
    v_add_f32 v10, v10, v14
    v_add_f32 v11, v11, v15
    v_perm_b32 v16, v8, v5, s68
    v_perm_b32 v17, v9, v5, s69
    v_perm_b32 v18, v10, v5, s70
    v_perm_b32 v19, v11, v5, s71
    s_mov_b32 exec_hi, 0
    s_add_u32 s58, s75, 0x600000
    buffer_store_dwordx4 v[16:19], v148, s[32:35], s58 offen
    buffer_store_dwordx4 v[16:19], v148, s[32:35], s75 offen sc1
    s_mov_b64 exec, -1
L_C_done:
    s_and_b32 s58, s54, 15
    s_cmp_ge_u32 s58, 8
    s_cbranch_scc1 L_W_notD
    s_cmp_lt_u32 s53, 4
    s_cbranch_scc1 L_D_red
    s_and_b32 s74, s53, 3
    v_bfe_u32 v130, v1, 2, 2
    v_lshl_add_u32 v131, v2, 5, v130
    v_lshlrev_b32 v131, 7, v131
    v_and_b32 v132, 3, v1
    v_lshl_add_u32 v131, v132, 3, v131
    v_lshrrev_b32 v130, 1, v130
    v_lshl_add_u32 v131, v130, 5, v131
    v_and_b32 v130, 1, v2
    v_lshl_add_u32 v131, v130, 6, v131
    s_lshl_b32 s73, s74, 14
    s_add_u32 s73, s73, 65536
    v_add_u32 v131, s73, v131
    v_xor_b32 v132, 0, v131
    v_xor_b32 v133, 32, v131
    v_xor_b32 v134, 64, v131
    v_xor_b32 v135, 96, v131
    ds_read_b64_tr_b16 v[8:9], v132 offset:0
    ds_read_b64_tr_b16 v[10:11], v132 offset:512
    ds_read_b64_tr_b16 v[12:13], v133 offset:0
    ds_read_b64_tr_b16 v[14:15], v133 offset:512
    ds_read_b64_tr_b16 v[16:17], v134 offset:0
    ds_read_b64_tr_b16 v[18:19], v134 offset:512
    ds_read_b64_tr_b16 v[20:21], v135 offset:0
    ds_read_b64_tr_b16 v[22:23], v135 offset:512
    ds_read_b64_tr_b16 v[24:25], v132 offset:1024
    ds_read_b64_tr_b16 v[26:27], v132 offset:1536
    ds_read_b64_tr_b16 v[28:29], v133 offset:1024
    ds_read_b64_tr_b16 v[30:31], v133 offset:1536
    ds_read_b64_tr_b16 v[32:33], v134 offset:1024
    ds_read_b64_tr_b16 v[34:35], v134 offset:1536
    ds_read_b64_tr_b16 v[36:37], v135 offset:1024
    ds_read_b64_tr_b16 v[38:39], v135 offset:1536
    ds_read_b64_tr_b16 v[40:41], v132 offset:2048
    ds_read_b64_tr_b16 v[42:43], v132 offset:2560
    ds_read_b64_tr_b16 v[44:45], v133 offset:2048
    ds_read_b64_tr_b16 v[46:47], v133 offset:2560
    ds_read_b64_tr_b16 v[48:49], v134 offset:2048
    ds_read_b64_tr_b16 v[50:51], v134 offset:2560
    ds_read_b64_tr_b16 v[52:53], v135 offset:2048
    ds_read_b64_tr_b16 v[54:55], v135 offset:2560
    ds_read_b64_tr_b16 v[56:57], v132 offset:3072
    ds_read_b64_tr_b16 v[58:59], v132 offset:3584
    ds_read_b64_tr_b16 v[60:61], v133 offset:3072
    ds_read_b64_tr_b16 v[62:63], v133 offset:3584
    ds_read_b64_tr_b16 v[64:65], v134 offset:3072
    ds_read_b64_tr_b16 v[66:67], v134 offset:3584
    ds_read_b64_tr_b16 v[68:69], v135 offset:3072
    ds_read_b64_tr_b16 v[70:71], v135 offset:3584
    v_lshrrev_b32 v136, 2, v3
    v_lshlrev_b32 v136, 6, v136
    v_lshl_add_u32 v136, v2, 4, v136
    s_lshl_b32 s58, s74, 10
    s_add_u32 s58, s58, 32768
    v_add_u32 v136, s58, v136
    v_lshrrev_b32 v137, 3, v3
    v_lshlrev_b32 v137, 10, v137
    v_lshl_add_u32 v137, v2, 7, v137
    v_and_b32 v138, 7, v3
    v_lshl_add_u32 v137, v138, 4, v137
    s_lshr_b32 s60, s54, 4
    s_lshl2_add_u32 s60, s60, s74
    s_lshl_b32 s60, s60, 12
    s_add_u32 s60, s60, 0xb0000
    s_add_u32 s61, s60, 0x600000
    s_mov_b32 s30, 400000
L_poll_19:
    s_and_b32 s75, s30, 31
    s_cmp_eq_u32 s75, 1
    s_cselect_b32 s75, s60, s61
    buffer_load_dwordx4 v[72:75], v137, s[32:35], s75 offen offset:0 sc1
    buffer_load_dwordx4 v[76:79], v137, s[32:35], s75 offen offset:512 sc1
    buffer_load_dwordx4 v[80:83], v137, s[32:35], s75 offen offset:2048 sc1
    buffer_load_dwordx4 v[84:87], v137, s[32:35], s75 offen offset:2560 sc1
L_pchk_21:
    s_waitcnt vmcnt(3)
    v_perm_b32 v138, v73, v72, s66
    v_perm_b32 v139, v75, v74, s67
    v_or_b32 v138, v138, v139
    v_xor_b32 v140, v138, v5
    s_waitcnt vmcnt(2)
    v_perm_b32 v138, v77, v76, s66
    v_perm_b32 v139, v79, v78, s67
    v_or_b32 v138, v138, v139
    v_bitop3_b32 v140, v140, v138, v5 bitop3:0xf6
    s_waitcnt vmcnt(1)
    v_perm_b32 v138, v81, v80, s66
    v_perm_b32 v139, v83, v82, s67
    v_or_b32 v138, v138, v139
    v_bitop3_b32 v140, v140, v138, v5 bitop3:0xf6
    s_waitcnt vmcnt(0)
    v_perm_b32 v138, v85, v84, s66
    v_perm_b32 v139, v87, v86, s67
    v_or_b32 v138, v138, v139
    v_bitop3_b32 v140, v140, v138, v5 bitop3:0xf6
    v_cmp_ne_u32 vcc, 0, v140
    s_nop 0
    s_and_b64 exec, exec, vcc
    s_cbranch_scc0 L_pdone_20
    s_sub_u32 s30, s30, 1
    s_cbranch_scc0 L_poll_19
L_pdone_20:
    s_mov_b64 exec, -1
    v_pk_add_f32 v[72:73], v[72:73], v[80:81]
    v_pk_add_f32 v[74:75], v[74:75], v[82:83]
    v_pk_add_f32 v[76:77], v[76:77], v[84:85]
    v_pk_add_f32 v[78:79], v[78:79], v[86:87]
    v_cvt_pk_bf16_f32 v88, v72, v73
    v_cvt_pk_bf16_f32 v89, v74, v75
    v_cvt_pk_bf16_f32 v90, v76, v77
    v_cvt_pk_bf16_f32 v91, v78, v79
    v_mov_b32_dpp v96, v88 quad_perm:[0,0,0,0] row_mask:0xf bank_mask:0xf
    v_mov_b32_dpp v97, v89 quad_perm:[0,0,0,0] row_mask:0xf bank_mask:0xf
    v_mov_b32_dpp v98, v90 quad_perm:[0,0,0,0] row_mask:0xf bank_mask:0xf
    v_mov_b32_dpp v99, v91 quad_perm:[0,0,0,0] row_mask:0xf bank_mask:0xf
    v_mov_b32_dpp v100, v88 quad_perm:[1,1,1,1] row_mask:0xf bank_mask:0xf
    v_mov_b32_dpp v101, v89 quad_perm:[1,1,1,1] row_mask:0xf bank_mask:0xf
    v_mov_b32_dpp v102, v90 quad_perm:[1,1,1,1] row_mask:0xf bank_mask:0xf
    v_mov_b32_dpp v103, v91 quad_perm:[1,1,1,1] row_mask:0xf bank_mask:0xf
    v_mov_b32_dpp v104, v88 quad_perm:[2,2,2,2] row_mask:0xf bank_mask:0xf
    v_mov_b32_dpp v105, v89 quad_perm:[2,2,2,2] row_mask:0xf bank_mask:0xf
    v_mov_b32_dpp v106, v90 quad_perm:[2,2,2,2] row_mask:0xf bank_mask:0xf
    v_mov_b32_dpp v107, v91 quad_perm:[2,2,2,2] row_mask:0xf bank_mask:0xf
    v_mov_b32_dpp v108, v88 quad_perm:[3,3,3,3] row_mask:0xf bank_mask:0xf
    v_mov_b32_dpp v109, v89 quad_perm:[3,3,3,3] row_mask:0xf bank_mask:0xf
    v_mov_b32_dpp v110, v90 quad_perm:[3,3,3,3] row_mask:0xf bank_mask:0xf
    v_mov_b32_dpp v111, v91 quad_perm:[3,3,3,3] row_mask:0xf bank_mask:0xf
    s_waitcnt lgkmcnt(0)
    v_mfma_f32_16x16x32_bf16 v[112:115], v[8:11], v[96:99], 0
    v_mfma_f32_16x16x32_bf16 v[116:119], v[12:15], v[96:99], 0
    v_mfma_f32_16x16x32_bf16 v[120:123], v[16:19], v[96:99], 0
    v_mfma_f32_16x16x32_bf16 v[124:127], v[20:23], v[96:99], 0
    v_mfma_f32_16x16x32_bf16 v[112:115], v[24:27], v[100:103], v[112:115]
    v_mfma_f32_16x16x32_bf16 v[116:119], v[28:31], v[100:103], v[116:119]
    v_mfma_f32_16x16x32_bf16 v[120:123], v[32:35], v[100:103], v[120:123]
    v_mfma_f32_16x16x32_bf16 v[124:127], v[36:39], v[100:103], v[124:127]
    v_mfma_f32_16x16x32_bf16 v[112:115], v[40:43], v[104:107], v[112:115]
    v_mfma_f32_16x16x32_bf16 v[116:119], v[44:47], v[104:107], v[116:119]
    v_mfma_f32_16x16x32_bf16 v[120:123], v[48:51], v[104:107], v[120:123]
    v_mfma_f32_16x16x32_bf16 v[124:127], v[52:55], v[104:107], v[124:127]
    v_mfma_f32_16x16x32_bf16 v[112:115], v[56:59], v[108:111], v[112:115]
    v_mfma_f32_16x16x32_bf16 v[116:119], v[60:63], v[108:111], v[116:119]
    v_mfma_f32_16x16x32_bf16 v[120:123], v[64:67], v[108:111], v[120:123]
    v_mfma_f32_16x16x32_bf16 v[124:127], v[68:71], v[108:111], v[124:127]
    s_mov_b32 exec_lo, 0x11111111
    s_mov_b32 exec_hi, 0x11111111
    s_nop 2
    ds_write_b128 v136, v[112:115] offset:0
    ds_write_b128 v136, v[116:119] offset:256
    ds_write_b128 v136, v[120:123] offset:512
    ds_write_b128 v136, v[124:127] offset:768
    s_mov_b64 exec, -1
    s_waitcnt lgkmcnt(0)
    s_barrier
    s_branch L_D_done
L_D_red:
    v_lshlrev_b32 v30, 4, v1
    v_add_u32 v31, 32768, v30
    s_lshr_b32 s61, s54, 4
    s_lshl_b32 s61, s61, 13
    s_lshl_b32 s59, s58, 10
    s_add_u32 s61, s61, s59
    s_add_u32 s61, s61, 0x80000
    s_barrier
    s_cmp_lg_u32 s53, 2
    s_cbranch_scc1 L_D_done
    ds_read_b128 v[8:11], v31 offset:0
    ds_read_b128 v[12:15], v31 offset:1024
    ds_read_b128 v[16:19], v31 offset:2048
    ds_read_b128 v[20:23], v31 offset:3072
    s_waitcnt lgkmcnt(0)
    v_pk_add_f32 v[8:9], v[8:9], v[16:17]
    v_pk_add_f32 v[10:11], v[10:11], v[18:19]
    v_pk_add_f32 v[12:13], v[12:13], v[20:21]
    v_pk_add_f32 v[14:15], v[14:15], v[22:23]
    v_pk_add_f32 v[8:9], v[8:9], v[12:13]
    v_pk_add_f32 v[10:11], v[10:11], v[14:15]
    v_perm_b32 v16, v8, v5, s68
    v_perm_b32 v17, v9, v5, s69
    v_perm_b32 v18, v10, v5, s70
    v_perm_b32 v19, v11, v5, s71
    buffer_store_dwordx4 v[16:19], v30, s[32:35], s61 offen sc1
L_D_done:
    s_endpgm
L_W_notD:
    s_cmp_ge_u32 s58, 15
    s_cbranch_scc1 L_W_end
    s_lshr_b32 s59, s54, 4
    s_mul_i32 s59, s59, 7
    s_add_u32 s59, s59, s58
    s_sub_u32 s55, s59, 8
    s_and_b32 s16, s54, 15
    s_lshr_b32 s17, s54, 4
    s_mov_b32 s40, s20
    s_and_b32 s41, s21, 0xffff
    s_mov_b32 s42, 0x1c0000
    s_mov_b32 s43, 0x20000
    s_mul_i32 s17, s17, 7
    s_add_u32 s17, s17, s16
    s_sub_u32 s17, s17, 8
    s_mul_i32 s31, s53, 229376
    s_lshl_b32 s52, s17, 6
    s_add_u32 s31, s31, s52
    v_lshrrev_b32 v160, 2, v1
    v_mul_u32_u24 v160, 3584, v160
    v_and_b32 v161, 3, v1
    v_lshl_add_u32 v160, v161, 4, v160
    v_xor_b32 v161, 32, v160
    s_lshl_b32 s52, s53, 12
    s_add_u32 s52, s52, 98304
    s_barrier
    s_add_u32 m0, s52, 0
    s_nop 0
    buffer_load_dwordx4 v160, s[40:43], s31 offen nt lds
    s_add_u32 s31, s31, 57344
    s_add_u32 m0, s52, 1024
    s_nop 0
    buffer_load_dwordx4 v160, s[40:43], s31 offen nt lds
    s_add_u32 s31, s31, 57344
    s_add_u32 m0, s52, 2048
    s_nop 0
    buffer_load_dwordx4 v161, s[40:43], s31 offen nt lds
    s_add_u32 s31, s31, 57344
    s_add_u32 m0, s52, 3072
    s_nop 0
    buffer_load_dwordx4 v161, s[40:43], s31 offen nt lds
    s_add_u32 s31, s31, 57344
    s_mov_b32 s48, s22
    s_and_b32 s49, s23, 0xffff
    s_mov_b32 s50, 0x1c0000
    s_mov_b32 s51, 0x20000
    v_lshlrev_b32 v7, 4, v1
    s_lshl_b32 s31, s55, 15
    s_lshl_b32 s73, s53, 12
    s_add_u32 s31, s31, s73
    s_add_u32 s73, s73, 131072
    s_add_u32 m0, s73, 0
    s_nop 0
    buffer_load_dwordx4 v7, s[48:51], s31 offen nt lds
    s_addk_i32 s31, 1024
    s_add_u32 m0, s73, 1024
    s_nop 0
    buffer_load_dwordx4 v7, s[48:51], s31 offen nt lds
    s_addk_i32 s31, 1024
    s_add_u32 m0, s73, 2048
    s_nop 0
    buffer_load_dwordx4 v7, s[48:51], s31 offen nt lds
    s_addk_i32 s31, 1024
    s_add_u32 m0, s73, 3072
    s_nop 0
    buffer_load_dwordx4 v7, s[48:51], s31 offen nt lds
    s_addk_i32 s31, 1024
    v_lshrrev_b32 v160, 2, v1
    v_mul_u32_u24 v160, 3584, v160
    v_and_b32 v161, 3, v1
    v_lshl_add_u32 v160, v161, 4, v160
    v_xor_b32 v161, 32, v160
    v_bfe_u32 v162, v1, 2, 2
    v_lshl_add_u32 v162, v2, 5, v162
    v_lshlrev_b32 v162, 6, v162
    v_and_b32 v163, 3, v1
    v_lshl_add_u32 v162, v163, 3, v162
    v_and_b32 v163, 1, v2
    v_lshl_add_u32 v162, v163, 5, v162
    v_xor_b32 v163, 32, v162
    s_lshl_b32 s73, s53, 13
    s_add_u32 s73, s73, 65536
    v_bfe_u32 v175, v1, 2, 2
    v_lshl_add_u32 v175, v2, 2, v175
    v_lshlrev_b32 v175, 10, v175
    v_and_b32 v254, 3, v1
    v_lshl_add_u32 v175, v254, 3, v175
    s_lshl_b32 s58, s53, 7
    s_add_u32 s58, s58, 131072
    v_add_u32 v175, s58, v175
    v_lshrrev_b32 v254, 2, v3
    v_lshlrev_b32 v254, 6, v254
    v_lshl_add_u32 v254, v2, 4, v254
    v_add_u32 v254, 45056, v254
    v_lshlrev_b32 v255, 4, v0
    s_lshl_b32 s57, s55, 13
    s_add_u32 s57, s57, 0x500000
    v_lshrrev_b32 v164, 2, v3
    v_lshlrev_b32 v164, 6, v164
    v_lshl_add_u32 v164, v2, 4, v164
    s_lshl_b32 s76, s53, 9
    s_add_u32 s76, s76, 32768
    v_add_u32 v164, s76, v164
    v_lshrrev_b32 v165, 5, v1
    v_lshlrev_b32 v165, 7, v165
    v_and_b32 v4, 31, v1
    v_add_u32 v165, v165, v4
    v_lshlrev_b32 v165, 4, v165
    v_add_u32 v165, 32768, v165
    s_cmp_ge_u32 s53, 4
    s_cbranch_scc1 L_E_red
    v_add_u32 v162, s73, v162
    v_add_u32 v163, s73, v163
    v_lshrrev_b32 v166, 2, v3
    v_lshlrev_b32 v168, 4, v3
    v_lshl_add_u32 v168, v2, 9, v168
    s_lshl_b32 s58, s53, 11
    s_add_u32 s58, s58, 0x80000
    s_lshl_b32 s59, s54, 13
    s_and_b32 s60, s59, 0xe000
    s_add_u32 s61, s58, s60
    s_addk_i32 s59, 8192
    s_and_b32 s60, s59, 0xe000
    s_add_u32 s73, s58, s60
    s_addk_i32 s59, 8192
    s_and_b32 s60, s59, 0xe000
    s_add_u32 s74, s58, s60
    s_addk_i32 s59, 8192
    s_and_b32 s60, s59, 0xe000
    s_add_u32 s75, s58, s60
    s_addk_i32 s59, 8192
    s_and_b32 s60, s59, 0xe000
    s_add_u32 s16, s58, s60
    s_addk_i32 s59, 8192
    s_and_b32 s60, s59, 0xe000
    s_add_u32 s17, s58, s60
    s_addk_i32 s59, 8192
    s_and_b32 s60, s59, 0xe000
    s_add_u32 s31, s58, s60
    s_addk_i32 s59, 8192
    s_and_b32 s60, s59, 0xe000
    s_add_u32 s52, s58, s60
    v_lshlrev_b32 v174, 3, v166
    s_lshl_b32 s58, s53, 5
    s_add_u32 s58, s58, 36864
    v_add_u32 v174, s58, v174
    v_mov_b32 v156, 0x3f803f80
    v_mov_b32 v157, 0x3f803f80
    v_mov_b32 v158, 0x3f803f80
    v_mov_b32 v159, 0x3f803f80
    ds_read_b64_tr_b16 v[8:9], v162 offset:0
    ds_read_b64_tr_b16 v[10:11], v162 offset:1024
    ds_read_b64_tr_b16 v[12:13], v163 offset:0
    ds_read_b64_tr_b16 v[14:15], v163 offset:1024
    ds_read_b64_tr_b16 v[16:17], v162 offset:256
    ds_read_b64_tr_b16 v[18:19], v162 offset:1280
    ds_read_b64_tr_b16 v[20:21], v163 offset:256
    ds_read_b64_tr_b16 v[22:23], v163 offset:1280
    ds_read_b64_tr_b16 v[24:25], v162 offset:512
    ds_read_b64_tr_b16 v[26:27], v162 offset:1536
    ds_read_b64_tr_b16 v[28:29], v163 offset:512
    ds_read_b64_tr_b16 v[30:31], v163 offset:1536
    ds_read_b64_tr_b16 v[32:33], v162 offset:768
    ds_read_b64_tr_b16 v[34:35], v162 offset:1792
    ds_read_b64_tr_b16 v[36:37], v163 offset:768
    ds_read_b64_tr_b16 v[38:39], v163 offset:1792
    s_waitcnt vmcnt(4)
    s_barrier
    ds_read_b64_tr_b16 v[40:41], v162 offset:32768
    ds_read_b64_tr_b16 v[42:43], v162 offset:33792
    ds_read_b64_tr_b16 v[44:45], v163 offset:32768
    ds_read_b64_tr_b16 v[46:47], v163 offset:33792
    ds_read_b64_tr_b16 v[48:49], v162 offset:33024
    ds_read_b64_tr_b16 v[50:51], v162 offset:34048
    ds_read_b64_tr_b16 v[52:53], v163 offset:33024
    ds_read_b64_tr_b16 v[54:55], v163 offset:34048
    ds_read_b64_tr_b16 v[56:57], v162 offset:33280
    ds_read_b64_tr_b16 v[58:59], v162 offset:34304
    ds_read_b64_tr_b16 v[60:61], v163 offset:33280
    ds_read_b64_tr_b16 v[62:63], v163 offset:34304
    ds_read_b64_tr_b16 v[64:65], v162 offset:33536
    ds_read_b64_tr_b16 v[66:67], v162 offset:34560
    ds_read_b64_tr_b16 v[68:69], v163 offset:33536
    ds_read_b64_tr_b16 v[70:71], v163 offset:34560
    s_waitcnt lgkmcnt(0)
    v_mfma_f32_16x16x32_bf16 v[176:179], v[8:11], v[156:159], 0
    v_mfma_f32_16x16x32_bf16 v[180:183], v[12:15], v[156:159], 0
    v_mfma_f32_16x16x32_bf16 v[176:179], v[16:19], v[156:159], v[176:179]
    v_mfma_f32_16x16x32_bf16 v[180:183], v[20:23], v[156:159], v[180:183]
    v_mfma_f32_16x16x32_bf16 v[176:179], v[24:27], v[156:159], v[176:179]
    v_mfma_f32_16x16x32_bf16 v[180:183], v[28:31], v[156:159], v[180:183]
    v_mfma_f32_16x16x32_bf16 v[176:179], v[32:35], v[156:159], v[176:179]
    v_mfma_f32_16x16x32_bf16 v[180:183], v[36:39], v[156:159], v[180:183]
    v_mfma_f32_16x16x32_bf16 v[184:187], v[40:43], v[156:159], 0
    v_mfma_f32_16x16x32_bf16 v[188:191], v[44:47], v[156:159], 0
    v_mfma_f32_16x16x32_bf16 v[184:187], v[48:51], v[156:159], v[184:187]
    v_mfma_f32_16x16x32_bf16 v[188:191], v[52:55], v[156:159], v[188:191]
    v_mfma_f32_16x16x32_bf16 v[184:187], v[56:59], v[156:159], v[184:187]
    v_mfma_f32_16x16x32_bf16 v[188:191], v[60:63], v[156:159], v[188:191]
    v_mfma_f32_16x16x32_bf16 v[184:187], v[64:67], v[156:159], v[184:187]
    v_mfma_f32_16x16x32_bf16 v[188:191], v[68:71], v[156:159], v[188:191]
    s_mov_b32 exec_lo, 0x11111111
    s_mov_b32 exec_hi, 0x11111111
    ds_write_b128 v164, v[176:179] offset:8192
    ds_write_b128 v164, v[180:183] offset:8448
    s_nop 2
    ds_write_b128 v164, v[184:187] offset:10240
    ds_write_b128 v164, v[188:191] offset:10496
    s_mov_b64 exec, -1
    s_waitcnt vmcnt(0) lgkmcnt(0)
    s_barrier
    ds_read_b64_tr_b16 v[224:225], v175 offset:0
    ds_read_b64_tr_b16 v[226:227], v175 offset:16384
    ds_read_b64_tr_b16 v[228:229], v175 offset:32
    ds_read_b64_tr_b16 v[230:231], v175 offset:16416
    ds_read_b64_tr_b16 v[232:233], v175 offset:64
    ds_read_b64_tr_b16 v[234:235], v175 offset:16448
    ds_read_b64_tr_b16 v[236:237], v175 offset:96
    ds_read_b64_tr_b16 v[238:239], v175 offset:16480
    s_mov_b32 s30, 400000
L_poll_22:
    buffer_load_dwordx4 v[72:75], v168, s[32:35], s61 offen offset:0 sc1
    buffer_load_dwordx4 v[76:79], v168, s[32:35], s61 offen offset:256 sc1
    buffer_load_dwordx4 v[80:83], v168, s[32:35], s73 offen offset:0 sc1
    buffer_load_dwordx4 v[84:87], v168, s[32:35], s73 offen offset:256 sc1
    buffer_load_dwordx4 v[88:91], v168, s[32:35], s74 offen offset:0 sc1
    buffer_load_dwordx4 v[92:95], v168, s[32:35], s74 offen offset:256 sc1
    buffer_load_dwordx4 v[96:99], v168, s[32:35], s75 offen offset:0 sc1
    buffer_load_dwordx4 v[100:103], v168, s[32:35], s75 offen offset:256 sc1
    buffer_load_dwordx4 v[104:107], v168, s[32:35], s16 offen offset:0 sc1
    buffer_load_dwordx4 v[108:111], v168, s[32:35], s16 offen offset:256 sc1
    buffer_load_dwordx4 v[112:115], v168, s[32:35], s17 offen offset:0 sc1
    buffer_load_dwordx4 v[116:119], v168, s[32:35], s17 offen offset:256 sc1
    buffer_load_dwordx4 v[120:123], v168, s[32:35], s31 offen offset:0 sc1
    buffer_load_dwordx4 v[124:127], v168, s[32:35], s31 offen offset:256 sc1
    buffer_load_dwordx4 v[128:131], v168, s[32:35], s52 offen offset:0 sc1
    buffer_load_dwordx4 v[132:135], v168, s[32:35], s52 offen offset:256 sc1
L_pchk_24:
    s_waitcnt vmcnt(15)
    v_perm_b32 v171, v73, v72, s66
    v_perm_b32 v172, v75, v74, s67
    v_or_b32 v171, v171, v172
    v_xor_b32 v173, v171, v5
    v_pk_add_f32 v[200:201], v[244:245], v[72:73]
    v_pk_add_f32 v[202:203], v[246:247], v[74:75]
    s_waitcnt vmcnt(14)
    v_perm_b32 v171, v77, v76, s66
    v_perm_b32 v172, v79, v78, s67
    v_or_b32 v171, v171, v172
    v_bitop3_b32 v173, v173, v171, v5 bitop3:0xf6
    v_pk_add_f32 v[204:205], v[248:249], v[76:77]
    v_pk_add_f32 v[206:207], v[250:251], v[78:79]
    s_waitcnt vmcnt(13)
    v_perm_b32 v171, v81, v80, s66
    v_perm_b32 v172, v83, v82, s67
    v_or_b32 v171, v171, v172
    v_bitop3_b32 v173, v173, v171, v5 bitop3:0xf6
    v_pk_add_f32 v[200:201], v[200:201], v[80:81]
    v_pk_add_f32 v[202:203], v[202:203], v[82:83]
    s_waitcnt vmcnt(12)
    v_perm_b32 v171, v85, v84, s66
    v_perm_b32 v172, v87, v86, s67
    v_or_b32 v171, v171, v172
    v_bitop3_b32 v173, v173, v171, v5 bitop3:0xf6
    v_pk_add_f32 v[204:205], v[204:205], v[84:85]
    v_pk_add_f32 v[206:207], v[206:207], v[86:87]
    s_waitcnt vmcnt(11)
    v_perm_b32 v171, v89, v88, s66
    v_perm_b32 v172, v91, v90, s67
    v_or_b32 v171, v171, v172
    v_bitop3_b32 v173, v173, v171, v5 bitop3:0xf6
    v_pk_add_f32 v[200:201], v[200:201], v[88:89]
    v_pk_add_f32 v[202:203], v[202:203], v[90:91]
    s_waitcnt vmcnt(10)
    v_perm_b32 v171, v93, v92, s66
    v_perm_b32 v172, v95, v94, s67
    v_or_b32 v171, v171, v172
    v_bitop3_b32 v173, v173, v171, v5 bitop3:0xf6
    v_pk_add_f32 v[204:205], v[204:205], v[92:93]
    v_pk_add_f32 v[206:207], v[206:207], v[94:95]
    s_waitcnt vmcnt(9)
    v_perm_b32 v171, v97, v96, s66
    v_perm_b32 v172, v99, v98, s67
    v_or_b32 v171, v171, v172
    v_bitop3_b32 v173, v173, v171, v5 bitop3:0xf6
    v_pk_add_f32 v[200:201], v[200:201], v[96:97]
    v_pk_add_f32 v[202:203], v[202:203], v[98:99]
    s_waitcnt vmcnt(8)
    v_perm_b32 v171, v101, v100, s66
    v_perm_b32 v172, v103, v102, s67
    v_or_b32 v171, v171, v172
    v_bitop3_b32 v173, v173, v171, v5 bitop3:0xf6
    v_pk_add_f32 v[204:205], v[204:205], v[100:101]
    v_pk_add_f32 v[206:207], v[206:207], v[102:103]
    s_waitcnt vmcnt(7)
    v_perm_b32 v171, v105, v104, s66
    v_perm_b32 v172, v107, v106, s67
    v_or_b32 v171, v171, v172
    v_bitop3_b32 v173, v173, v171, v5 bitop3:0xf6
    v_pk_add_f32 v[200:201], v[200:201], v[104:105]
    v_pk_add_f32 v[202:203], v[202:203], v[106:107]
    s_waitcnt vmcnt(6)
    v_perm_b32 v171, v109, v108, s66
    v_perm_b32 v172, v111, v110, s67
    v_or_b32 v171, v171, v172
    v_bitop3_b32 v173, v173, v171, v5 bitop3:0xf6
    v_pk_add_f32 v[204:205], v[204:205], v[108:109]
    v_pk_add_f32 v[206:207], v[206:207], v[110:111]
    s_waitcnt vmcnt(5)
    v_perm_b32 v171, v113, v112, s66
    v_perm_b32 v172, v115, v114, s67
    v_or_b32 v171, v171, v172
    v_bitop3_b32 v173, v173, v171, v5 bitop3:0xf6
    v_pk_add_f32 v[200:201], v[200:201], v[112:113]
    v_pk_add_f32 v[202:203], v[202:203], v[114:115]
    s_waitcnt vmcnt(4)
    v_perm_b32 v171, v117, v116, s66
    v_perm_b32 v172, v119, v118, s67
    v_or_b32 v171, v171, v172
    v_bitop3_b32 v173, v173, v171, v5 bitop3:0xf6
    v_pk_add_f32 v[204:205], v[204:205], v[116:117]
    v_pk_add_f32 v[206:207], v[206:207], v[118:119]
    s_waitcnt vmcnt(3)
    v_perm_b32 v171, v121, v120, s66
    v_perm_b32 v172, v123, v122, s67
    v_or_b32 v171, v171, v172
    v_bitop3_b32 v173, v173, v171, v5 bitop3:0xf6
    v_pk_add_f32 v[200:201], v[200:201], v[120:121]
    v_pk_add_f32 v[202:203], v[202:203], v[122:123]
    s_waitcnt vmcnt(2)
    v_perm_b32 v171, v125, v124, s66
    v_perm_b32 v172, v127, v126, s67
    v_or_b32 v171, v171, v172
    v_bitop3_b32 v173, v173, v171, v5 bitop3:0xf6
    v_pk_add_f32 v[204:205], v[204:205], v[124:125]
    v_pk_add_f32 v[206:207], v[206:207], v[126:127]
    s_waitcnt vmcnt(1)
    v_perm_b32 v171, v129, v128, s66
    v_perm_b32 v172, v131, v130, s67
    v_or_b32 v171, v171, v172
    v_bitop3_b32 v173, v173, v171, v5 bitop3:0xf6
    v_pk_add_f32 v[200:201], v[200:201], v[128:129]
    v_pk_add_f32 v[202:203], v[202:203], v[130:131]
    s_waitcnt vmcnt(0)
    v_perm_b32 v171, v133, v132, s66
    v_perm_b32 v172, v135, v134, s67
    v_or_b32 v171, v171, v172
    v_bitop3_b32 v173, v173, v171, v5 bitop3:0xf6
    v_pk_add_f32 v[204:205], v[204:205], v[132:133]
    v_pk_add_f32 v[206:207], v[206:207], v[134:135]
    v_cmp_ne_u32 vcc, 0, v173
    s_nop 0
    s_and_b64 exec, exec, vcc
    s_cbranch_scc0 L_pdone_23
    s_sub_u32 s30, s30, 1
    s_cbranch_scc0 L_poll_22
L_pdone_23:
    s_mov_b64 exec, -1
    v_cvt_pk_bf16_f32 v136, v200, v201
    v_cvt_pk_bf16_f32 v137, v202, v203
    v_cvt_pk_bf16_f32 v138, v204, v205
    v_cvt_pk_bf16_f32 v139, v206, v207
    v_mov_b32_dpp v140, v136 quad_perm:[0,0,0,0] row_mask:0xf bank_mask:0xf
    v_mov_b32_dpp v141, v137 quad_perm:[0,0,0,0] row_mask:0xf bank_mask:0xf
    v_mov_b32_dpp v142, v138 quad_perm:[0,0,0,0] row_mask:0xf bank_mask:0xf
    v_mov_b32_dpp v143, v139 quad_perm:[0,0,0,0] row_mask:0xf bank_mask:0xf
    v_mov_b32_dpp v144, v136 quad_perm:[1,1,1,1] row_mask:0xf bank_mask:0xf
    v_mov_b32_dpp v145, v137 quad_perm:[1,1,1,1] row_mask:0xf bank_mask:0xf
    v_mov_b32_dpp v146, v138 quad_perm:[1,1,1,1] row_mask:0xf bank_mask:0xf
    v_mov_b32_dpp v147, v139 quad_perm:[1,1,1,1] row_mask:0xf bank_mask:0xf
    v_mov_b32_dpp v148, v136 quad_perm:[2,2,2,2] row_mask:0xf bank_mask:0xf
    v_mov_b32_dpp v149, v137 quad_perm:[2,2,2,2] row_mask:0xf bank_mask:0xf
    v_mov_b32_dpp v150, v138 quad_perm:[2,2,2,2] row_mask:0xf bank_mask:0xf
    v_mov_b32_dpp v151, v139 quad_perm:[2,2,2,2] row_mask:0xf bank_mask:0xf
    v_mov_b32_dpp v152, v136 quad_perm:[3,3,3,3] row_mask:0xf bank_mask:0xf
    v_mov_b32_dpp v153, v137 quad_perm:[3,3,3,3] row_mask:0xf bank_mask:0xf
    v_mov_b32_dpp v154, v138 quad_perm:[3,3,3,3] row_mask:0xf bank_mask:0xf
    v_mov_b32_dpp v155, v139 quad_perm:[3,3,3,3] row_mask:0xf bank_mask:0xf
    v_mfma_f32_16x16x32_bf16 v[176:179], v[8:11], v[140:143], 0
    v_mfma_f32_16x16x32_bf16 v[180:183], v[12:15], v[140:143], 0
    v_mfma_f32_16x16x32_bf16 v[184:187], v[40:43], v[140:143], 0
    v_mfma_f32_16x16x32_bf16 v[188:191], v[44:47], v[140:143], 0
    v_mfma_f32_16x16x32_bf16 v[192:195], v[156:159], v[140:143], 0
    v_mfma_f32_16x16x32_bf16 v[196:199], v[140:143], v[140:143], 0
    v_mfma_f32_16x16x32_bf16 v[176:179], v[16:19], v[144:147], v[176:179]
    v_mfma_f32_16x16x32_bf16 v[180:183], v[20:23], v[144:147], v[180:183]
    v_mfma_f32_16x16x32_bf16 v[184:187], v[48:51], v[144:147], v[184:187]
    v_mfma_f32_16x16x32_bf16 v[188:191], v[52:55], v[144:147], v[188:191]
    v_mfma_f32_16x16x32_bf16 v[192:195], v[156:159], v[144:147], v[192:195]
    v_mfma_f32_16x16x32_bf16 v[196:199], v[144:147], v[144:147], v[196:199]
    v_mfma_f32_16x16x32_bf16 v[176:179], v[24:27], v[148:151], v[176:179]
    v_mfma_f32_16x16x32_bf16 v[180:183], v[28:31], v[148:151], v[180:183]
    v_mfma_f32_16x16x32_bf16 v[184:187], v[56:59], v[148:151], v[184:187]
    v_mfma_f32_16x16x32_bf16 v[188:191], v[60:63], v[148:151], v[188:191]
    v_mfma_f32_16x16x32_bf16 v[192:195], v[156:159], v[148:151], v[192:195]
    v_mfma_f32_16x16x32_bf16 v[196:199], v[148:151], v[148:151], v[196:199]
    v_mfma_f32_16x16x32_bf16 v[176:179], v[32:35], v[152:155], v[176:179]
    v_mfma_f32_16x16x32_bf16 v[180:183], v[36:39], v[152:155], v[180:183]
    v_mfma_f32_16x16x32_bf16 v[184:187], v[64:67], v[152:155], v[184:187]
    v_mfma_f32_16x16x32_bf16 v[188:191], v[68:71], v[152:155], v[188:191]
    v_mfma_f32_16x16x32_bf16 v[192:195], v[156:159], v[152:155], v[192:195]
    v_mfma_f32_16x16x32_bf16 v[196:199], v[152:155], v[152:155], v[196:199]
    s_mov_b32 exec_lo, 0x11111111
    s_mov_b32 exec_hi, 0x11111111
    s_nop 0
    ds_write_b128 v164, v[176:179] offset:0
    ds_write_b128 v164, v[180:183] offset:256
    ds_write_b128 v164, v[184:187] offset:2048
    ds_write_b128 v164, v[188:191] offset:2304
    s_mov_b32 exec_lo, 0x100001
    s_mov_b32 exec_hi, 0x10000100
    ds_write2_b32 v174, v192, v196 offset0:0 offset1:1
    s_mov_b64 exec, -1
    s_waitcnt lgkmcnt(0)
    s_barrier
    s_branch L_E_down
L_E_red:
    v_lshlrev_b32 v60, 4, v3
    v_and_b32 v61, 1, v2
    v_lshl_add_u32 v60, v61, 3, v60
    v_add_u32 v60, 45056, v60
    v_bfe_u32 v61, v1, 2, 2
    v_lshlrev_b32 v61, 3, v61
    v_add_u32 v61, 36864, v61
    s_waitcnt vmcnt(4)
    s_barrier
    s_waitcnt vmcnt(0)
    s_barrier
    ds_read_b64_tr_b16 v[224:225], v175 offset:0
    ds_read_b64_tr_b16 v[226:227], v175 offset:16384
    ds_read_b64_tr_b16 v[228:229], v175 offset:32
    ds_read_b64_tr_b16 v[230:231], v175 offset:16416
    ds_read_b64_tr_b16 v[232:233], v175 offset:64
    ds_read_b64_tr_b16 v[234:235], v175 offset:16448
    ds_read_b64_tr_b16 v[236:237], v175 offset:96
    ds_read_b64_tr_b16 v[238:239], v175 offset:16480
    ds_read_b128 v[24:27], v165 offset:8192
    ds_read_b128 v[28:31], v165 offset:8704
    ds_read_b128 v[32:35], v165 offset:9216
    ds_read_b128 v[36:39], v165 offset:9728
    s_waitcnt lgkmcnt(0)
    v_pk_add_f32 v[24:25], v[24:25], v[32:33]
    v_pk_add_f32 v[26:27], v[26:27], v[34:35]
    v_pk_add_f32 v[28:29], v[28:29], v[36:37]
    v_pk_add_f32 v[30:31], v[30:31], v[38:39]
    v_pk_add_f32 v[24:25], v[24:25], v[28:29]
    v_pk_add_f32 v[26:27], v[26:27], v[30:31]
    s_barrier
    s_cmp_lg_u32 s53, 4
    s_cbranch_scc1 L_E_down
    ds_read_b64 v[40:41], v61 offset:0
    ds_read_b64 v[42:43], v61 offset:32
    ds_read_b64 v[44:45], v61 offset:64
    ds_read_b64 v[46:47], v61 offset:96
    ds_read_b128 v[8:11], v165 offset:0
    ds_read_b128 v[12:15], v165 offset:512
    ds_read_b128 v[16:19], v165 offset:1024
    ds_read_b128 v[20:23], v165 offset:1536
    s_waitcnt lgkmcnt(4)
    v_pk_add_f32 v[40:41], v[40:41], v[44:45]
    v_pk_add_f32 v[42:43], v[42:43], v[46:47]
    v_pk_add_f32 v[40:41], v[40:41], v[42:43]
    v_mul_f32 v40, 0x3b000000, v40
    v_mul_f32 v42, v40, v40
    v_mov_b32 v43, 0x3b000000
    v_fma_f32 v42, v41, v43, -v42
    v_max_f32 v42, 0, v42
    v_add_f32 v42, 0x3727c5ac, v42
    v_rsq_f32 v42, v42
    s_waitcnt lgkmcnt(0)
    v_pk_add_f32 v[8:9], v[8:9], v[16:17]
    v_pk_add_f32 v[10:11], v[10:11], v[18:19]
    v_pk_add_f32 v[12:13], v[12:13], v[20:21]
    v_pk_add_f32 v[14:15], v[14:15], v[22:23]
    v_pk_add_f32 v[8:9], v[8:9], v[12:13]
    v_pk_add_f32 v[10:11], v[10:11], v[14:15]
    v_pk_fma_f32 v[8:9], v[24:25], v[40:41], v[8:9] op_sel_hi:[1,0,1] neg_lo:[1,0,0] neg_hi:[1,0,0]
    v_pk_fma_f32 v[10:11], v[26:27], v[40:41], v[10:11] op_sel_hi:[1,0,1] neg_lo:[1,0,0] neg_hi:[1,0,0]
    v_pk_mul_f32 v[8:9], v[8:9], v[42:43] op_sel_hi:[1,0]
    v_pk_mul_f32 v[10:11], v[10:11], v[42:43] op_sel_hi:[1,0]
    v_mul_f32 v16, 0xbfb8aa3b, v8
    v_mul_f32 v17, 0xbfb8aa3b, v9
    v_mul_f32 v18, 0xbfb8aa3b, v10
    v_mul_f32 v19, 0xbfb8aa3b, v11
    v_mov_b32 v12, v8
    v_mov_b32 v13, v9
    v_mov_b32 v14, v10
    v_mov_b32 v15, v11
    v_exp_f32 v16, v16
    v_exp_f32 v17, v17
    v_exp_f32 v18, v18
    v_exp_f32 v19, v19
    v_permlane32_swap_b32 v12, v20
    v_permlane32_swap_b32 v13, v21
    v_permlane32_swap_b32 v14, v22
    v_permlane32_swap_b32 v15, v23
    v_add_f32 v16, 1.0, v16
    v_add_f32 v17, 1.0, v17
    v_add_f32 v18, 1.0, v18
    v_add_f32 v19, 1.0, v19
    v_rcp_f32 v16, v16
    v_rcp_f32 v17, v17
    v_rcp_f32 v18, v18
    v_rcp_f32 v19, v19
    v_mul_f32 v16, v16, v8
    v_mul_f32 v17, v17, v9
    v_mul_f32 v18, v18, v10
    v_mul_f32 v19, v19, v11
    v_mul_f32 v16, v16, v20
    v_mul_f32 v17, v17, v21
    v_mul_f32 v18, v18, v22
    v_mul_f32 v19, v19, v23
    v_cvt_pk_bf16_f32 v12, v16, v17
    v_cvt_pk_bf16_f32 v13, v18, v19
    s_mov_b32 exec_hi, 0
    ds_write_b64 v60, v[12:13]
    s_mov_b64 exec, -1
    s_waitcnt lgkmcnt(0)
L_E_down:
    s_barrier
    ds_read_b128 v[8:11], v254
    s_waitcnt lgkmcnt(0)
    v_mfma_f32_16x16x32_bf16 v[12:15], v[224:227], v[8:11], 0
    v_mfma_f32_16x16x32_bf16 v[16:19], v[228:231], v[8:11], 0
    v_mfma_f32_16x16x32_bf16 v[20:23], v[232:235], v[8:11], 0
    v_mfma_f32_16x16x32_bf16 v[24:27], v[236:239], v[8:11], 0
    s_mov_b32 exec_lo, 0x11111111
    s_mov_b32 exec_hi, 0x11111111
    s_nop 2
    v_perm_b32 v240, v12, v5, s68
    v_perm_b32 v241, v13, v5, s69
    v_perm_b32 v242, v14, v5, s70
    v_perm_b32 v243, v15, v5, s71
    s_mov_b32 exec_lo, 0x22222222
    s_mov_b32 exec_hi, 0x22222222
    v_perm_b32 v240, v16, v5, s68
    v_perm_b32 v241, v17, v5, s69
    v_perm_b32 v242, v18, v5, s70
    v_perm_b32 v243, v19, v5, s71
    s_mov_b32 exec_lo, 0x44444444
    s_mov_b32 exec_hi, 0x44444444
    v_perm_b32 v240, v20, v5, s68
    v_perm_b32 v241, v21, v5, s69
    v_perm_b32 v242, v22, v5, s70
    v_perm_b32 v243, v23, v5, s71
    s_mov_b32 exec_lo, 0x88888888
    s_mov_b32 exec_hi, 0x88888888
    v_perm_b32 v240, v24, v5, s68
    v_perm_b32 v241, v25, v5, s69
    v_perm_b32 v242, v26, v5, s70
    v_perm_b32 v243, v27, v5, s71
    s_mov_b64 exec, -1
    buffer_store_dwordx4 v[240:243], v255, s[32:35], s57 offen sc1
L_E_done:
L_W_end:
    s_endpgm
L_exit:
    s_endpgm
.section .rodata,"a"
.p2align 6
.amdhsa_kernel sequential_preLN__compressed_kv_cla__swiglu_ffn__decode_kernel
  .amdhsa_next_free_vgpr 256
  .amdhsa_next_free_sgpr 102
  .amdhsa_accum_offset 256
  .amdhsa_group_segment_fixed_size 0
  .amdhsa_kernarg_size 104
  .amdhsa_user_sgpr_count 2
  .amdhsa_user_sgpr_kernarg_segment_ptr 1
  .amdhsa_system_sgpr_workgroup_id_x 1
.end_amdhsa_kernel
```
